```python
import torch

def _softmax(x, axis=-1):
    return torch.softmax(x, dim=axis)
def _gelu(x):
    return torch.nn.functional.gelu(x, approximate="tanh")
def _silu(x):
    return torch.nn.functional.silu(x)
def _sigmoid(x):
    return torch.sigmoid(x)
def _layernorm(x, axis=-1, eps=1e-5):
    m = x.mean(dim=axis, keepdim=True)
    v = x.var(dim=axis, keepdim=True, unbiased=False)
    return (x - m) / torch.sqrt(v + eps)
def _scatter_add(tgt, idx, src, axis=0):
    return tgt.clone().index_add_(axis, idx, src)
def _segment_sum(src, seg, n):
    out = torch.zeros((n,) + src.shape[1:], dtype=src.dtype)
    return out.index_add_(0, seg, src)
def _pad(x, pw):
    flat = tuple(v for pair in reversed(pw) for v in pair)
    return torch.nn.functional.pad(x, flat)

kernel_name = 'sequential_preLN__gqa_block_cached__geglu_ffn__decode'

def setup_inputs():

    _w = (lambda a: (lambda t: t.to(torch.bfloat16) if t.is_floating_point() else t)(torch.as_tensor(a)))
    def _A_setup():
        B, Sq, D = 8, 1, 576
        Hq, Hkv, Sk, Dh = 32, 16, 4096, 128
        assert Hq % Hkv == 0, (Hq, Hkv)
        return {
            "x": _w((lambda *s: torch.randn(*s, dtype=torch.bfloat16) * 0.05)(B, Sq, D)),
            "k_cache": _w((lambda *s: torch.randn(*s, dtype=torch.bfloat16) * 3.2)(B, Hkv, Sk, Dh)),
            "v_cache": _w((lambda *s: torch.randn(*s, dtype=torch.bfloat16) * 0.4)(B, Hkv, Sk, Dh)),
            "wq": _w((lambda *s: torch.randn(*s, dtype=torch.bfloat16) * 3.2)(D, Hq * Dh) * (D ** -0.5)),
            "wo": _w((lambda *s: torch.randn(*s, dtype=torch.bfloat16) * 0.4)(Hq * Dh, D) * ((Hq * Dh) ** -0.5)),
        }
    _A_in = _A_setup()

    def _B_setup():
        B, S, D, F = 8, 1, 576, 4608
        return {
            "x": _w((lambda *s: torch.randn(*s, dtype=torch.bfloat16) * 0.05)(B, S, D)),
            "w_gate": _w((lambda *s: torch.randn(*s, dtype=torch.bfloat16) * 0.05)(D, F)),
            "w_up": _w((lambda *s: torch.randn(*s, dtype=torch.bfloat16) * 0.05)(D, F)),
            "w_down": _w((lambda *s: torch.randn(*s, dtype=torch.bfloat16) * 0.05)(F, D)),
        }
    _B_in = _B_setup()

    return {
        "A_x": _A_in["x"],
        "A_k_cache": _A_in["k_cache"],
        "A_v_cache": _A_in["v_cache"],
        "A_wq": _A_in["wq"],
        "A_wo": _A_in["wo"],
        "B_x": _B_in["x"],
        "B_w_gate": _B_in["w_gate"],
        "B_w_up": _B_in["w_up"],
        "B_w_down": _B_in["w_down"],
    }

def reference(A_x, A_k_cache, A_v_cache, A_wq, A_wo, B_x, B_w_gate, B_w_up, B_w_down):
    def _A_ref(x, k_cache, v_cache, wq, wo):
        B, Sq, D = x.shape
        Hq, Dh = 32, 128
        Hkv = k_cache.shape[1]
        rep = Hq // Hkv
        q = (lambda x, *d: x.permute(*d))((x @ wq).reshape(B, Sq, Hq, Dh), 0, 2, 1, 3)
        k = (lambda x, n, axis: torch.repeat_interleave(x, n, dim=axis))(k_cache, rep, axis=1)
        v = (lambda x, n, axis: torch.repeat_interleave(x, n, dim=axis))(v_cache, rep, axis=1)
        scores = torch.einsum("bhqd,bhkd->bhqk", q, k) * (Dh ** -0.5)
        p = _softmax(scores, axis=-1)
        o = torch.einsum("bhqk,bhkd->bhqd", p, v)
        return (lambda x, *d: x.permute(*d))(o, 0, 2, 1, 3).reshape(B, Sq, Hq * Dh) @ wo

    def _B_ref(x, w_gate, w_up, w_down):
        return (_gelu(x @ w_gate) * (x @ w_up)) @ w_down

    x = A_x
    h = x + _A_ref(_layernorm(x, axis=-1), A_k_cache, A_v_cache, A_wq, A_wo)
    h2 = h + _B_ref(_layernorm(h, axis=-1), B_w_gate, B_w_up, B_w_down)
    return h2
```

```asm
; @launch grid=(256,1,1) block=(512,1,1) lds=163072
.amdgcn_target "amdgcn-amd-amdhsa--gfx950"
.text
.globl sequential_preLN__gqa_block_cached__geglu_ffn__decode_kernel
.p2align 8
.type sequential_preLN__gqa_block_cached__geglu_ffn__decode_kernel,@function
sequential_preLN__gqa_block_cached__geglu_ffn__decode_kernel:
  s_cmp_ge_u32 s2, 256
  s_cbranch_scc1 L_end
  s_load_dwordx16 s[4:19], s[0:1], 0
  s_load_dwordx8 s[20:27], s[0:1], 64
  v_and_b32 v1, 63, v0
  v_lshrrev_b32 v4, 6, v0
  v_mov_b32 v2, 0
  v_mov_b32 v3, 1
  v_readfirstlane_b32 s3, v4
  v_lshrrev_b32 v7, 4, v1
  v_and_b32 v8, 15, v1
  s_and_b32 s28, s2, 7
  s_lshr_b32 s29, s2, 3
  s_lshr_b32 s64, s29, 4
  s_lshl_b32 s30, s28, 1
  s_add_u32 s30, s30, s64
  s_and_b32 s33, s29, 15
  s_lshr_b32 s31, s33, 1
  s_and_b32 s32, s33, 1
  s_lshl_b32 s38, s30, 4
  s_add_u32 s38, s38, s33
  s_mul_i32 s34, s28, 18
  s_lshr_b32 s67, s29, 1
  s_add_u32 s98, s67, 16
  s_bitcmp1_b32 s29, 0
  s_cselect_b32 s98, s98, s67
  s_add_u32 s34, s34, s98
  s_cmp_lt_u32 s3, 4
  s_cbranch_scc1 L_stream
  s_sub_u32 s39, s3, 4
  v_lshrrev_b32 v40, 5, v1
  v_mul_u32_u24 v42, 1152, v40
  v_and_b32 v41, 31, v1
  v_lshl_add_u32 v9, v41, 2, v42
  s_mul_i32 s64, s39, 2304
  s_waitcnt lgkmcnt(0)
  s_mov_b32 s60, s4
  s_and_b32 s61, s5, 0xffff
  s_mov_b32 s62, 0x2400
  s_mov_b32 s63, 0x20000
  buffer_load_dword v10, v9, s[60:63], s64 offen offset:0
  buffer_load_dword v11, v9, s[60:63], s64 offen offset:128
  buffer_load_dword v12, v9, s[60:63], s64 offen offset:256
  buffer_load_dword v13, v9, s[60:63], s64 offen offset:384
  buffer_load_dword v14, v9, s[60:63], s64 offen offset:512
  buffer_load_dword v15, v9, s[60:63], s64 offen offset:640
  buffer_load_dword v16, v9, s[60:63], s64 offen offset:768
  buffer_load_dword v17, v9, s[60:63], s64 offen offset:896
  buffer_load_dword v18, v9, s[60:63], s64 offen offset:1024
  s_mov_b32 s52, s26
  s_and_b32 s53, s27, 0xffff
  s_mov_b32 s54, 0x20000000
  s_mov_b32 s55, 0x20000
  s_mov_b32 s56, s24
  s_and_b32 s57, s25, 0xffff
  s_mov_b32 s58, 0x100
  s_mov_b32 s59, 0x20000
  s_cmp_eq_u32 s39, 0
  s_cbranch_scc0 L_a_not0
  s_mov_b32 s48, s10
  s_and_b32 s49, s11, 0xffff
  s_mov_b32 s50, 0x480000
  s_mov_b32 s51, 0x20000
  v_lshrrev_b32 v43, 3, v1
  v_lshlrev_b32 v43, 13, v43
  v_and_b32 v44, 7, v1
  v_lshl_add_u32 v42, v44, 4, v43
  s_and_b32 s35, s33, 3
  s_lshr_b32 s36, s33, 2
  s_mul_i32 s37, s35, 5
  s_cmp_eq_u32 s35, 3
  s_cselect_b32 s37, 14, s37
  s_lshl_b32 s68, s37, 18
  s_lshl_b32 s64, s30, 9
  s_add_u32 s68, s68, s64
  s_lshl_b32 s64, s36, 7
  s_add_u32 s68, s68, s64
  s_mov_b32 m0, 27904
  s_add_u32 s67, s68, 0
  buffer_load_dwordx4 v42, s[48:51], s67 offen nt lds
  s_mov_b32 m0, 28928
  s_add_u32 s67, s68, 65536
  buffer_load_dwordx4 v42, s[48:51], s67 offen nt lds
  s_mov_b32 m0, 29952
  s_add_u32 s67, s68, 131072
  buffer_load_dwordx4 v42, s[48:51], s67 offen nt lds
  s_mov_b32 m0, 30976
  s_add_u32 s67, s68, 196608
  buffer_load_dwordx4 v42, s[48:51], s67 offen nt lds
  s_mov_b32 m0, 32000
  s_add_u32 s67, s68, 262144
  buffer_load_dwordx4 v42, s[48:51], s67 offen nt lds
  s_mov_b32 m0, 33024
  s_add_u32 s67, s68, 327680
  buffer_load_dwordx4 v42, s[48:51], s67 offen nt lds
  s_mov_b32 m0, 34048
  s_add_u32 s67, s68, 393216
  buffer_load_dwordx4 v42, s[48:51], s67 offen nt lds
  s_mov_b32 m0, 35072
  s_add_u32 s67, s68, 458752
  buffer_load_dwordx4 v42, s[48:51], s67 offen nt lds
  s_mov_b32 m0, 36096
  s_add_u32 s67, s68, 524288
  buffer_load_dwordx4 v42, s[48:51], s67 offen nt lds
  s_mov_b32 m0, 37120
  s_add_u32 s67, s68, 589824
  buffer_load_dwordx4 v42, s[48:51], s67 offen nt lds
  s_mov_b32 m0, 38144
  s_add_u32 s67, s68, 655360
  buffer_load_dwordx4 v42, s[48:51], s67 offen nt lds
  s_mov_b32 m0, 39168
  s_add_u32 s67, s68, 720896
  buffer_load_dwordx4 v42, s[48:51], s67 offen nt lds
  s_mov_b32 m0, 40192
  s_add_u32 s67, s68, 786432
  buffer_load_dwordx4 v42, s[48:51], s67 offen nt lds
  s_mov_b32 m0, 41216
  s_add_u32 s67, s68, 851968
  buffer_load_dwordx4 v42, s[48:51], s67 offen nt lds
  s_mov_b32 m0, 42240
  s_add_u32 s67, s68, 917504
  buffer_load_dwordx4 v42, s[48:51], s67 offen nt lds
  s_mov_b32 m0, 43264
  s_add_u32 s67, s68, 983040
  buffer_load_dwordx4 v42, s[48:51], s67 offen nt lds
  s_cmp_ge_u32 s35, 2
  s_cbranch_scc1 L_a0_wqd
  s_mov_b32 m0, 44288
  s_add_u32 s67, s68, 1048576
  buffer_load_dwordx4 v42, s[48:51], s67 offen nt lds
  s_mov_b32 m0, 45312
  s_add_u32 s67, s68, 1114112
  buffer_load_dwordx4 v42, s[48:51], s67 offen nt lds
  s_mov_b32 m0, 46336
  s_add_u32 s67, s68, 1179648
  buffer_load_dwordx4 v42, s[48:51], s67 offen nt lds
  s_mov_b32 m0, 47360
  s_add_u32 s67, s68, 1245184
  buffer_load_dwordx4 v42, s[48:51], s67 offen nt lds
L_a0_wqd:
  s_cmp_eq_u32 s2, 0
  s_cbranch_scc0 L_a0_nn
  s_memrealtime s[92:93]
  s_waitcnt lgkmcnt(0)
  s_or_b32 s92, s92, 1
  v_mov_b32 v44, s92
  v_mov_b32 v45, s93
  s_mov_b64 exec, 1
  buffer_store_dwordx2 v[44:45], v2, s[56:59], 0 offen sc1
  s_mov_b64 exec, -1
L_a0_nn:
  v_lshlrev_b32 v43, 2, v1
  ds_write_b32 v43, v2
  s_waitcnt lgkmcnt(0)
L_a_not0:
  s_barrier
  v_mul_u32_u24 v40, 1168, v40
  v_lshl_add_u32 v40, v41, 2, v40
  s_mul_i32 s64, s39, 2336
  v_add_u32 v6, s64, v40
  v_bfe_u32 v40, v1, 2, 2
  v_lshl_add_u32 v5, v7, 3, v40
  v_and_b32 v41, 3, v1
  v_lshlrev_b32 v38, 3, v41
  v_and_b32 v40, 7, v8
  v_mul_u32_u24 v40, 1168, v40
  v_lshl_add_u32 v4, v7, 4, v40
  s_cmp_eq_u32 s39, 0
  s_cbranch_scc1 L_a0_xw
  s_waitcnt vmcnt(0)
L_a0_xw:
  s_waitcnt vmcnt(16)
  v_lshlrev_b32 v20, 16, v10
  v_and_b32 v21, 0xffff0000, v10
  v_lshlrev_b32 v22, 16, v11
  v_and_b32 v23, 0xffff0000, v11
  v_lshlrev_b32 v24, 16, v12
  v_and_b32 v25, 0xffff0000, v12
  v_lshlrev_b32 v26, 16, v13
  v_and_b32 v27, 0xffff0000, v13
  v_lshlrev_b32 v28, 16, v14
  v_and_b32 v29, 0xffff0000, v14
  v_lshlrev_b32 v30, 16, v15
  v_and_b32 v31, 0xffff0000, v15
  v_lshlrev_b32 v32, 16, v16
  v_and_b32 v33, 0xffff0000, v16
  v_lshlrev_b32 v34, 16, v17
  v_and_b32 v35, 0xffff0000, v17
  v_lshlrev_b32 v36, 16, v18
  v_and_b32 v37, 0xffff0000, v18
  v_pk_add_f32 v[40:41], v[20:21], v[22:23]
  v_pk_add_f32 v[42:43], v[24:25], v[26:27]
  v_pk_add_f32 v[44:45], v[28:29], v[30:31]
  v_pk_add_f32 v[46:47], v[32:33], v[34:35]
  v_pk_add_f32 v[40:41], v[40:41], v[36:37]
  v_pk_add_f32 v[42:43], v[42:43], v[44:45]
  v_pk_add_f32 v[40:41], v[40:41], v[46:47]
  v_pk_add_f32 v[40:41], v[40:41], v[42:43]
  v_add_f32 v40, v40, v41
  s_nop 1
  v_add_f32_dpp v40, v40, v40 quad_perm:[1,0,3,2] row_mask:0xf bank_mask:0xf
  s_nop 1
  v_add_f32_dpp v40, v40, v40 quad_perm:[2,3,0,1] row_mask:0xf bank_mask:0xf
  s_nop 1
  v_add_f32_dpp v40, v40, v40 row_half_mirror row_mask:0xf bank_mask:0xf
  s_nop 1
  v_add_f32_dpp v40, v40, v40 row_mirror row_mask:0xf bank_mask:0xf
  v_mov_b32 v41, v40
  s_nop 1
  v_permlane16_swap_b32 v40, v41
  s_nop 1
  v_add_f32 v40, v40, v41
  v_mul_f32 v40, 0x3ae38e39, v40
  v_mov_b32 v41, v40
  v_pk_add_f32 v[44:45], v[20:21], v[40:41] neg_lo:[0,1] neg_hi:[0,1]
  v_pk_mul_f32 v[50:51], v[44:45], v[44:45]
  v_pk_add_f32 v[46:47], v[22:23], v[40:41] neg_lo:[0,1] neg_hi:[0,1]
  v_pk_mul_f32 v[52:53], v[46:47], v[46:47]
  v_pk_add_f32 v[48:49], v[24:25], v[40:41] neg_lo:[0,1] neg_hi:[0,1]
  v_pk_mul_f32 v[54:55], v[48:49], v[48:49]
  v_pk_add_f32 v[44:45], v[26:27], v[40:41] neg_lo:[0,1] neg_hi:[0,1]
  v_pk_fma_f32 v[50:51], v[44:45], v[44:45], v[50:51]
  v_pk_add_f32 v[46:47], v[28:29], v[40:41] neg_lo:[0,1] neg_hi:[0,1]
  v_pk_fma_f32 v[52:53], v[46:47], v[46:47], v[52:53]
  v_pk_add_f32 v[48:49], v[30:31], v[40:41] neg_lo:[0,1] neg_hi:[0,1]
  v_pk_fma_f32 v[54:55], v[48:49], v[48:49], v[54:55]
  v_pk_add_f32 v[44:45], v[32:33], v[40:41] neg_lo:[0,1] neg_hi:[0,1]
  v_pk_fma_f32 v[50:51], v[44:45], v[44:45], v[50:51]
  v_pk_add_f32 v[46:47], v[34:35], v[40:41] neg_lo:[0,1] neg_hi:[0,1]
  v_pk_fma_f32 v[52:53], v[46:47], v[46:47], v[52:53]
  v_pk_add_f32 v[48:49], v[36:37], v[40:41] neg_lo:[0,1] neg_hi:[0,1]
  v_pk_fma_f32 v[54:55], v[48:49], v[48:49], v[54:55]
  v_pk_add_f32 v[50:51], v[50:51], v[52:53]
  v_pk_add_f32 v[50:51], v[50:51], v[54:55]
  v_add_f32 v42, v50, v51
  s_nop 1
  v_add_f32_dpp v42, v42, v42 quad_perm:[1,0,3,2] row_mask:0xf bank_mask:0xf
  s_nop 1
  v_add_f32_dpp v42, v42, v42 quad_perm:[2,3,0,1] row_mask:0xf bank_mask:0xf
  s_nop 1
  v_add_f32_dpp v42, v42, v42 row_half_mirror row_mask:0xf bank_mask:0xf
  s_nop 1
  v_add_f32_dpp v42, v42, v42 row_mirror row_mask:0xf bank_mask:0xf
  v_mov_b32 v43, v42
  s_nop 1
  v_permlane16_swap_b32 v42, v43
  s_nop 1
  v_add_f32 v42, v42, v43
  v_mul_f32 v42, 0x3ae38e39, v42
  v_cvt_pk_bf16_f32 v43, v40, v42
  v_lshlrev_b32 v44, 16, v43
  v_and_b32 v46, 0xffff0000, v43
  v_mov_b32 v45, v44
  v_add_f32 v46, 0x3727c5ac, v46
  v_cvt_pk_bf16_f32 v46, v46, v46
  v_lshlrev_b32 v46, 16, v46
  v_sqrt_f32 v46, v46
  v_pk_add_f32 v[20:21], v[20:21], v[44:45] neg_lo:[0,1] neg_hi:[0,1]
  v_pk_add_f32 v[22:23], v[22:23], v[44:45] neg_lo:[0,1] neg_hi:[0,1]
  v_pk_add_f32 v[24:25], v[24:25], v[44:45] neg_lo:[0,1] neg_hi:[0,1]
  v_pk_add_f32 v[26:27], v[26:27], v[44:45] neg_lo:[0,1] neg_hi:[0,1]
  v_pk_add_f32 v[28:29], v[28:29], v[44:45] neg_lo:[0,1] neg_hi:[0,1]
  v_pk_add_f32 v[30:31], v[30:31], v[44:45] neg_lo:[0,1] neg_hi:[0,1]
  v_pk_add_f32 v[32:33], v[32:33], v[44:45] neg_lo:[0,1] neg_hi:[0,1]
  v_pk_add_f32 v[34:35], v[34:35], v[44:45] neg_lo:[0,1] neg_hi:[0,1]
  v_pk_add_f32 v[36:37], v[36:37], v[44:45] neg_lo:[0,1] neg_hi:[0,1]
  v_cvt_pk_bf16_f32 v46, v46, v46
  v_lshlrev_b32 v46, 16, v46
  v_rcp_f32 v46, v46
  v_cvt_pk_bf16_f32 v10, v20, v21
  v_cvt_pk_bf16_f32 v11, v22, v23
  v_cvt_pk_bf16_f32 v12, v24, v25
  v_cvt_pk_bf16_f32 v13, v26, v27
  v_cvt_pk_bf16_f32 v14, v28, v29
  v_cvt_pk_bf16_f32 v15, v30, v31
  v_cvt_pk_bf16_f32 v16, v32, v33
  v_cvt_pk_bf16_f32 v17, v34, v35
  v_cvt_pk_bf16_f32 v18, v36, v37
  v_mov_b32 v47, v46
  v_lshlrev_b32 v20, 16, v10
  v_and_b32 v21, 0xffff0000, v10
  v_lshlrev_b32 v22, 16, v11
  v_and_b32 v23, 0xffff0000, v11
  v_lshlrev_b32 v24, 16, v12
  v_and_b32 v25, 0xffff0000, v12
  v_lshlrev_b32 v26, 16, v13
  v_and_b32 v27, 0xffff0000, v13
  v_lshlrev_b32 v28, 16, v14
  v_and_b32 v29, 0xffff0000, v14
  v_lshlrev_b32 v30, 16, v15
  v_and_b32 v31, 0xffff0000, v15
  v_lshlrev_b32 v32, 16, v16
  v_and_b32 v33, 0xffff0000, v16
  v_lshlrev_b32 v34, 16, v17
  v_and_b32 v35, 0xffff0000, v17
  v_lshlrev_b32 v36, 16, v18
  v_and_b32 v37, 0xffff0000, v18
  v_pk_mul_f32 v[20:21], v[20:21], v[46:47]
  v_pk_mul_f32 v[22:23], v[22:23], v[46:47]
  v_pk_mul_f32 v[24:25], v[24:25], v[46:47]
  v_pk_mul_f32 v[26:27], v[26:27], v[46:47]
  v_pk_mul_f32 v[28:29], v[28:29], v[46:47]
  v_pk_mul_f32 v[30:31], v[30:31], v[46:47]
  v_pk_mul_f32 v[32:33], v[32:33], v[46:47]
  v_pk_mul_f32 v[34:35], v[34:35], v[46:47]
  v_pk_mul_f32 v[36:37], v[36:37], v[46:47]
  v_cvt_pk_bf16_f32 v10, v20, v21
  ds_write_b32 v6, v10 offset:10368
  v_cvt_pk_bf16_f32 v11, v22, v23
  ds_write_b32 v6, v11 offset:10496
  v_cvt_pk_bf16_f32 v12, v24, v25
  ds_write_b32 v6, v12 offset:10624
  v_cvt_pk_bf16_f32 v13, v26, v27
  ds_write_b32 v6, v13 offset:10752
  v_cvt_pk_bf16_f32 v14, v28, v29
  ds_write_b32 v6, v14 offset:10880
  v_cvt_pk_bf16_f32 v15, v30, v31
  ds_write_b32 v6, v15 offset:11008
  v_cvt_pk_bf16_f32 v16, v32, v33
  ds_write_b32 v6, v16 offset:11136
  v_cvt_pk_bf16_f32 v17, v34, v35
  ds_write_b32 v6, v17 offset:11264
  v_cvt_pk_bf16_f32 v18, v36, v37
  ds_write_b32 v6, v18 offset:11392
  s_mov_b64 exec, 1
  ds_add_u32 v2, v3 offset:0
  s_mov_b64 exec, -1
  s_cmp_eq_u32 s39, 0
  s_cbranch_scc0 L_a_init
  buffer_load_dwordx2 v[254:255], v2, s[56:59], 0 offen sc1
  v_lshl_add_u32 v43, v5, 7, v38
  s_lshl_b32 s64, s37, 6
  v_add_u32 v44, s64, v4
  s_mov_b32 s94, 4000000
L_lw_1:
  ds_read_b32 v40, v2 offset:0
  s_waitcnt lgkmcnt(0)
  v_readfirstlane_b32 s95, v40
  s_cmp_ge_u32 s95, 4
  s_cbranch_scc1 L_lwd_2
  s_sub_u32 s94, s94, 1
  s_cmp_lg_u32 s94, 0
  s_cbranch_scc1 L_lw_1
  s_branch L_end
L_lwd_2:
  s_waitcnt vmcnt(1)
  ds_read_b128 v[148:151], v44 offset:10368
  ds_read_b64_tr_b16 v[132:133], v43 offset:27904
  ds_read_b64_tr_b16 v[134:135], v43 offset:28416
  ds_read_b64_tr_b16 v[136:137], v43 offset:27936
  ds_read_b64_tr_b16 v[138:139], v43 offset:28448
  ds_read_b64_tr_b16 v[140:141], v43 offset:27968
  ds_read_b64_tr_b16 v[142:143], v43 offset:28480
  ds_read_b64_tr_b16 v[144:145], v43 offset:28000
  ds_read_b64_tr_b16 v[146:147], v43 offset:28512
  s_waitcnt lgkmcnt(6)
  v_mfma_f32_16x16x32_bf16 v[180:183], v[132:135], v[148:151], 0
  s_waitcnt lgkmcnt(4)
  v_mfma_f32_16x16x32_bf16 v[184:187], v[136:139], v[148:151], 0
  s_waitcnt lgkmcnt(2)
  v_mfma_f32_16x16x32_bf16 v[188:191], v[140:143], v[148:151], 0
  s_waitcnt lgkmcnt(0)
  v_mfma_f32_16x16x32_bf16 v[192:195], v[144:147], v[148:151], 0
  ds_read_b128 v[172:175], v44 offset:10432
  ds_read_b64_tr_b16 v[156:157], v43 offset:32000
  ds_read_b64_tr_b16 v[158:159], v43 offset:32512
  ds_read_b64_tr_b16 v[160:161], v43 offset:32032
  ds_read_b64_tr_b16 v[162:163], v43 offset:32544
  ds_read_b64_tr_b16 v[164:165], v43 offset:32064
  ds_read_b64_tr_b16 v[166:167], v43 offset:32576
  ds_read_b64_tr_b16 v[168:169], v43 offset:32096
  ds_read_b64_tr_b16 v[170:171], v43 offset:32608
  s_waitcnt lgkmcnt(6)
  v_mfma_f32_16x16x32_bf16 v[180:183], v[156:159], v[172:175], v[180:183]
  s_waitcnt lgkmcnt(4)
  v_mfma_f32_16x16x32_bf16 v[184:187], v[160:163], v[172:175], v[184:187]
  s_waitcnt lgkmcnt(2)
  v_mfma_f32_16x16x32_bf16 v[188:191], v[164:167], v[172:175], v[188:191]
  s_waitcnt lgkmcnt(0)
  v_mfma_f32_16x16x32_bf16 v[192:195], v[168:171], v[172:175], v[192:195]
  ds_read_b128 v[148:151], v44 offset:10496
  ds_read_b64_tr_b16 v[132:133], v43 offset:36096
  ds_read_b64_tr_b16 v[134:135], v43 offset:36608
  ds_read_b64_tr_b16 v[136:137], v43 offset:36128
  ds_read_b64_tr_b16 v[138:139], v43 offset:36640
  ds_read_b64_tr_b16 v[140:141], v43 offset:36160
  ds_read_b64_tr_b16 v[142:143], v43 offset:36672
  ds_read_b64_tr_b16 v[144:145], v43 offset:36192
  ds_read_b64_tr_b16 v[146:147], v43 offset:36704
  s_waitcnt lgkmcnt(6)
  v_mfma_f32_16x16x32_bf16 v[180:183], v[132:135], v[148:151], v[180:183]
  s_waitcnt lgkmcnt(4)
  v_mfma_f32_16x16x32_bf16 v[184:187], v[136:139], v[148:151], v[184:187]
  s_waitcnt lgkmcnt(2)
  v_mfma_f32_16x16x32_bf16 v[188:191], v[140:143], v[148:151], v[188:191]
  s_waitcnt lgkmcnt(0)
  v_mfma_f32_16x16x32_bf16 v[192:195], v[144:147], v[148:151], v[192:195]
  ds_read_b128 v[172:175], v44 offset:10560
  ds_read_b64_tr_b16 v[156:157], v43 offset:40192
  ds_read_b64_tr_b16 v[158:159], v43 offset:40704
  ds_read_b64_tr_b16 v[160:161], v43 offset:40224
  ds_read_b64_tr_b16 v[162:163], v43 offset:40736
  ds_read_b64_tr_b16 v[164:165], v43 offset:40256
  ds_read_b64_tr_b16 v[166:167], v43 offset:40768
  ds_read_b64_tr_b16 v[168:169], v43 offset:40288
  ds_read_b64_tr_b16 v[170:171], v43 offset:40800
  s_waitcnt lgkmcnt(6)
  v_mfma_f32_16x16x32_bf16 v[180:183], v[156:159], v[172:175], v[180:183]
  s_waitcnt lgkmcnt(4)
  v_mfma_f32_16x16x32_bf16 v[184:187], v[160:163], v[172:175], v[184:187]
  s_waitcnt lgkmcnt(2)
  v_mfma_f32_16x16x32_bf16 v[188:191], v[164:167], v[172:175], v[188:191]
  s_waitcnt lgkmcnt(0)
  v_mfma_f32_16x16x32_bf16 v[192:195], v[168:171], v[172:175], v[192:195]
  s_cmp_ge_u32 s35, 2
  s_cbranch_scc1 L_a0_qdone
  ds_read_b128 v[148:151], v44 offset:10624
  ds_read_b64_tr_b16 v[132:133], v43 offset:44288
  ds_read_b64_tr_b16 v[134:135], v43 offset:44800
  ds_read_b64_tr_b16 v[136:137], v43 offset:44320
  ds_read_b64_tr_b16 v[138:139], v43 offset:44832
  ds_read_b64_tr_b16 v[140:141], v43 offset:44352
  ds_read_b64_tr_b16 v[142:143], v43 offset:44864
  ds_read_b64_tr_b16 v[144:145], v43 offset:44384
  ds_read_b64_tr_b16 v[146:147], v43 offset:44896
  s_waitcnt lgkmcnt(6)
  v_mfma_f32_16x16x32_bf16 v[180:183], v[132:135], v[148:151], v[180:183]
  s_waitcnt lgkmcnt(4)
  v_mfma_f32_16x16x32_bf16 v[184:187], v[136:139], v[148:151], v[184:187]
  s_waitcnt lgkmcnt(2)
  v_mfma_f32_16x16x32_bf16 v[188:191], v[140:143], v[148:151], v[188:191]
  s_waitcnt lgkmcnt(0)
  v_mfma_f32_16x16x32_bf16 v[192:195], v[144:147], v[148:151], v[192:195]
L_a0_qdone:
  v_and_b32 v42, 7, v8
  v_lshlrev_b32 v42, 8, v42
  v_lshrrev_b32 v45, 3, v8
  v_lshl_add_u32 v42, v45, 6, v42
  v_lshl_add_u32 v42, v7, 4, v42
  s_lshl_b32 s64, s38, 11
  s_add_u32 s64, s64, 4194304
  s_nop 3
  v_mov_b32_dpp v180, v184 row_shr:8 row_mask:0xf bank_mask:0xc
  v_mov_b32_dpp v181, v185 row_shr:8 row_mask:0xf bank_mask:0xc
  v_mov_b32_dpp v182, v186 row_shr:8 row_mask:0xf bank_mask:0xc
  v_mov_b32_dpp v183, v187 row_shr:8 row_mask:0xf bank_mask:0xc
  buffer_store_dwordx4 v[180:183], v42, s[52:55], s64 offen offset:0 sc1
  v_mov_b32_dpp v188, v192 row_shr:8 row_mask:0xf bank_mask:0xc
  v_mov_b32_dpp v189, v193 row_shr:8 row_mask:0xf bank_mask:0xc
  v_mov_b32_dpp v190, v194 row_shr:8 row_mask:0xf bank_mask:0xc
  v_mov_b32_dpp v191, v195 row_shr:8 row_mask:0xf bank_mask:0xc
  buffer_store_dwordx4 v[188:191], v42, s[52:55], s64 offen offset:128 sc1
  s_mov_b32 s94, 400000
L_nz_3:
  s_waitcnt vmcnt(0)
  v_readfirstlane_b32 s92, v254
  v_readfirstlane_b32 s93, v255
  s_cmp_lg_u32 s92, 0
  s_cbranch_scc1 L_nzd_4
  s_sleep 4
  buffer_load_dwordx2 v[254:255], v2, s[56:59], 0 offen sc1
  s_sub_u32 s94, s94, 1
  s_cmp_lg_u32 s94, 0
  s_cbranch_scc1 L_nz_3
  s_branch L_end
L_nzd_4:
  s_lshl_b32 s64, s38, 7
  s_add_u32 s64, s64, 4718592
  s_mov_b64 exec, 1
  buffer_store_dwordx2 v[254:255], v2, s[52:55], s64 offen sc1
  ds_write_b64 v2, v[254:255] offset:336
  ds_add_u32 v2, v3 offset:40
  s_mov_b64 exec, 0xffff
  v_lshlrev_b32 v42, 7, v1
  s_lshl_b32 s64, s30, 11
  s_add_u32 s64, s64, 4718592
  s_mov_b32 s94, 400000
L_qf_5:
  buffer_load_dwordx2 v[44:45], v42, s[52:55], s64 offen sc1
  s_waitcnt vmcnt(0)
  v_xor_b32 v44, s92, v44
  v_xor_b32 v45, s93, v45
  v_or_b32 v44, v44, v45
  v_cmp_ne_u32 vcc, 0, v44
  s_cmp_eq_u64 vcc, 0
  s_cbranch_scc1 L_qfd_6
  s_sub_u32 s94, s94, 1
  s_cmp_lg_u32 s94, 0
  s_cbranch_scc1 L_qf_5
  s_branch L_end
L_qfd_6:
  s_mov_b64 exec, -1
  v_lshlrev_b32 v42, 13, v7
  v_lshl_add_u32 v42, v8, 4, v42
  s_lshl_b32 s64, s30, 15
  s_lshl_b32 s67, s31, 8
  s_add_u32 s64, s64, s67
  s_add_u32 s64, s64, 4194304
  buffer_load_dwordx4 v[132:135], v42, s[52:55], s64 offen offset:0 sc1
  buffer_load_dwordx4 v[136:139], v42, s[52:55], s64 offen offset:2048 sc1
  s_add_u32 s64, s64, 4096
  buffer_load_dwordx4 v[140:143], v42, s[52:55], s64 offen offset:0 sc1
  buffer_load_dwordx4 v[144:147], v42, s[52:55], s64 offen offset:2048 sc1
  v_lshlrev_b32 v43, 3, v1
  s_waitcnt vmcnt(0)
  v_add_f32 v132, v132, v136
  v_add_f32 v140, v140, v144
  v_add_f32 v133, v133, v137
  v_add_f32 v141, v141, v145
  v_add_f32 v134, v134, v138
  v_add_f32 v142, v142, v146
  v_add_f32 v135, v135, v139
  v_add_f32 v143, v143, v147
  v_add_f32 v132, v132, v140
  v_add_f32 v133, v133, v141
  v_add_f32 v134, v134, v142
  v_add_f32 v135, v135, v143
  v_cvt_pk_bf16_f32 v132, v132, v133
  v_cvt_pk_bf16_f32 v133, v134, v135
  ds_write_b64 v43, v[132:133] offset:512
  s_mov_b64 exec, 1
  ds_add_u32 v2, v3 offset:8
  s_mov_b64 exec, -1
  s_branch L_a_pref
L_a_init:
  v_mov_b32 v204, -1
  v_mov_b32 v205, -1
  v_mov_b32 v206, -1
  v_mov_b32 v207, -1
  v_lshlrev_b32 v40, 4, v1
  s_cmp_eq_u32 s39, 1
  s_cbranch_scc0 L_a_23
  s_lshl_b32 s64, s38, 10
  s_add_u32 s64, s64, 131072
  buffer_store_dwordx4 v[204:207], v40, s[52:55], s64 offen sc1
  s_lshl_b32 s64, s38, 6
  s_add_u32 s64, s64, 65536
  s_mov_b64 exec, 1
  buffer_store_dwordx4 v[204:207], v40, s[52:55], s64 offen sc1
  s_mov_b64 exec, -1
  s_cmp_lt_u32 s33, 9
  s_cbranch_scc0 L_a1_noo
  s_mul_i32 s64, s30, 18432
  s_lshl_b32 s67, s33, 11
  s_add_u32 s64, s64, s67
  s_add_u32 s64, s64, 393216
  buffer_store_dwordx4 v[204:207], v40, s[52:55], s64 offen sc1
  buffer_store_dwordx4 v[204:207], v40, s[52:55], s64 offen offset:1024 sc1
L_a1_noo:
  s_cmp_ge_u32 s29, 23
  s_cbranch_scc0 L_a_iw
  s_mul_i32 s64, s28, 9
  s_add_u32 s64, s64, s29
  s_sub_u32 s64, s64, 23
  s_lshl_b32 s64, s64, 7
  s_add_u32 s64, s64, 720896
  s_mov_b64 exec, 0xff
  buffer_store_dwordx4 v[204:207], v40, s[52:55], s64 offen sc1
  s_add_u32 s64, s64, 0x4000
  buffer_store_dwordx4 v[204:207], v40, s[52:55], s64 offen sc1
  s_add_u32 s64, s64, 0x4000
  buffer_store_dwordx4 v[204:207], v40, s[52:55], s64 offen sc1
  s_add_u32 s64, s64, 0x4000
  buffer_store_dwordx4 v[204:207], v40, s[52:55], s64 offen sc1
  s_mov_b64 exec, -1
  s_branch L_a_iw
L_a_23:
  s_cmp_lt_u32 s98, 18
  s_cbranch_scc0 L_a_iw
  s_mul_i32 s64, s34, 18432
  s_sub_u32 s67, s39, 2
  s_mul_i32 s67, s67, 9216
  s_add_u32 s64, s64, s67
  s_add_u32 s64, s64, 1048576
  buffer_store_dwordx4 v[204:207], v40, s[52:55], s64 offen offset:0 sc1
  buffer_store_dwordx4 v[204:207], v40, s[52:55], s64 offen offset:1024 sc1
  buffer_store_dwordx4 v[204:207], v40, s[52:55], s64 offen offset:2048 sc1
  buffer_store_dwordx4 v[204:207], v40, s[52:55], s64 offen offset:3072 sc1
  s_add_u32 s64, s64, 4096
  buffer_store_dwordx4 v[204:207], v40, s[52:55], s64 offen offset:0 sc1
  buffer_store_dwordx4 v[204:207], v40, s[52:55], s64 offen offset:1024 sc1
  buffer_store_dwordx4 v[204:207], v40, s[52:55], s64 offen offset:2048 sc1
  buffer_store_dwordx4 v[204:207], v40, s[52:55], s64 offen offset:3072 sc1
  s_add_u32 s64, s64, 4096
  buffer_store_dwordx4 v[204:207], v40, s[52:55], s64 offen offset:0 sc1
L_a_iw:
  s_waitcnt vmcnt(0)
  s_mov_b64 exec, 1
  ds_add_u32 v2, v3 offset:4
  s_mov_b64 exec, -1
  s_cmp_eq_u32 s39, 1
  s_cbranch_scc0 L_a_iw2
  s_mov_b32 s94, 4000000
L_lw_7:
  ds_read_b32 v40, v2 offset:40
  s_waitcnt lgkmcnt(0)
  v_readfirstlane_b32 s95, v40
  s_cmp_ge_u32 s95, 1
  s_cbranch_scc1 L_lwd_8
  s_sleep 2
  s_sub_u32 s94, s94, 1
  s_cmp_lg_u32 s94, 0
  s_cbranch_scc1 L_lw_7
  s_branch L_end
L_lwd_8:
  ds_read_b64 v[254:255], v2 offset:336
  s_mov_b32 s94, 4000000
L_lw_9:
  ds_read_b32 v40, v2 offset:4
  s_waitcnt lgkmcnt(0)
  v_readfirstlane_b32 s95, v40
  s_cmp_ge_u32 s95, 3
  s_cbranch_scc1 L_lwd_10
  s_sleep 1
  s_sub_u32 s94, s94, 1
  s_cmp_lg_u32 s94, 0
  s_cbranch_scc1 L_lw_9
  s_branch L_end
L_lwd_10:
  v_readfirstlane_b32 s92, v254
  v_readfirstlane_b32 s93, v255
  s_lshl_b32 s64, s38, 3
  s_add_u32 s64, s64, 4784128
  s_mov_b64 exec, 1
  buffer_store_dwordx2 v[254:255], v2, s[52:55], s64 offen sc1
  s_mov_b64 exec, -1
L_a_iw2:
  s_mov_b32 s94, 4000000
L_lw_11:
  ds_read_b32 v40, v2 offset:8
  s_waitcnt lgkmcnt(0)
  v_readfirstlane_b32 s95, v40
  s_cmp_ge_u32 s95, 1
  s_cbranch_scc1 L_lwd_12
  s_sleep 4
  s_sub_u32 s94, s94, 1
  s_cmp_lg_u32 s94, 0
  s_cbranch_scc1 L_lw_11
  s_branch L_end
L_lwd_12:
L_a_pref:
  s_cmp_lt_u32 s98, 18
  s_cbranch_scc0 L_a_nogu
  s_and_b32 s64, s39, 1
  s_cmp_eq_u32 s64, 0
  s_cselect_b32 s48, s16, s18
  s_cselect_b32 s49, s17, s19
  s_and_b32 s49, s49, 0xffff
  s_mov_b32 s50, 0x510000
  s_mov_b32 s51, 0x20000
  s_lshl_b32 s68, s34, 6
  s_lshr_b32 s64, s39, 1
  s_mul_i32 s64, s64, 2654208
  s_add_u32 s68, s68, s64
  v_lshrrev_b32 v40, 2, v1
  v_mul_u32_u24 v40, 9216, v40
  v_and_b32 v41, 3, v1
  v_lshl_add_u32 v50, v41, 4, v40
  s_mul_i32 s65, s39, 9216
  s_add_u32 s65, s65, 27904
  v_lshl_add_u32 v43, v5, 6, v38
  v_add_u32 v43, s65, v43
  s_add_u32 m0, s65, 0
  s_add_u32 s67, s68, 0
  buffer_load_dwordx4 v50, s[48:51], s67 offen nt lds
  s_waitcnt vmcnt(0)
  s_add_u32 m0, s65, 1024
  s_add_u32 s67, s68, 147456
  buffer_load_dwordx4 v50, s[48:51], s67 offen nt lds
  s_waitcnt vmcnt(0)
  s_add_u32 m0, s65, 2048
  s_add_u32 s67, s68, 294912
  buffer_load_dwordx4 v50, s[48:51], s67 offen nt lds
  s_waitcnt vmcnt(0)
  s_add_u32 m0, s65, 3072
  s_add_u32 s67, s68, 442368
  buffer_load_dwordx4 v50, s[48:51], s67 offen nt lds
  s_waitcnt vmcnt(0)
  s_add_u32 m0, s65, 4096
  s_add_u32 s67, s68, 589824
  buffer_load_dwordx4 v50, s[48:51], s67 offen nt lds
  s_waitcnt vmcnt(0)
  s_add_u32 m0, s65, 5120
  s_add_u32 s67, s68, 737280
  buffer_load_dwordx4 v50, s[48:51], s67 offen nt lds
  s_waitcnt vmcnt(0)
  s_add_u32 m0, s65, 6144
  s_add_u32 s67, s68, 884736
  buffer_load_dwordx4 v50, s[48:51], s67 offen nt lds
  s_waitcnt vmcnt(0)
  s_add_u32 m0, s65, 7168
  s_add_u32 s67, s68, 1032192
  buffer_load_dwordx4 v50, s[48:51], s67 offen nt lds
  s_waitcnt vmcnt(0)
  ds_read_b64_tr_b16 v[132:133], v43 offset:0
  ds_read_b64_tr_b16 v[134:135], v43 offset:256
  ds_read_b64_tr_b16 v[136:137], v43 offset:32
  ds_read_b64_tr_b16 v[138:139], v43 offset:288
  ds_read_b64_tr_b16 v[140:141], v43 offset:2048
  ds_read_b64_tr_b16 v[142:143], v43 offset:2304
  ds_read_b64_tr_b16 v[144:145], v43 offset:2080
  ds_read_b64_tr_b16 v[146:147], v43 offset:2336
  s_waitcnt lgkmcnt(0)
  ds_read_b64_tr_b16 v[148:149], v43 offset:4096
  ds_read_b64_tr_b16 v[150:151], v43 offset:4352
  ds_read_b64_tr_b16 v[152:153], v43 offset:4128
  ds_read_b64_tr_b16 v[154:155], v43 offset:4384
  ds_read_b64_tr_b16 v[156:157], v43 offset:6144
  ds_read_b64_tr_b16 v[158:159], v43 offset:6400
  ds_read_b64_tr_b16 v[160:161], v43 offset:6176
  ds_read_b64_tr_b16 v[162:163], v43 offset:6432
  s_waitcnt lgkmcnt(0)
  s_waitcnt lgkmcnt(0)
  s_add_u32 m0, s65, 0
  s_add_u32 s67, s68, 1179648
  buffer_load_dwordx4 v50, s[48:51], s67 offen nt lds
  s_waitcnt vmcnt(0)
  s_add_u32 m0, s65, 1024
  s_add_u32 s67, s68, 1327104
  buffer_load_dwordx4 v50, s[48:51], s67 offen nt lds
  s_waitcnt vmcnt(0)
  s_add_u32 m0, s65, 2048
  s_add_u32 s67, s68, 1474560
  buffer_load_dwordx4 v50, s[48:51], s67 offen nt lds
  s_waitcnt vmcnt(0)
  s_add_u32 m0, s65, 3072
  s_add_u32 s67, s68, 1622016
  buffer_load_dwordx4 v50, s[48:51], s67 offen nt lds
  s_waitcnt vmcnt(0)
  s_add_u32 m0, s65, 4096
  s_add_u32 s67, s68, 1769472
  buffer_load_dwordx4 v50, s[48:51], s67 offen nt lds
  s_waitcnt vmcnt(0)
  s_add_u32 m0, s65, 5120
  s_add_u32 s67, s68, 1916928
  buffer_load_dwordx4 v50, s[48:51], s67 offen nt lds
  s_waitcnt vmcnt(0)
  s_add_u32 m0, s65, 6144
  s_add_u32 s67, s68, 2064384
  buffer_load_dwordx4 v50, s[48:51], s67 offen nt lds
  s_waitcnt vmcnt(0)
  s_add_u32 m0, s65, 7168
  s_add_u32 s67, s68, 2211840
  buffer_load_dwordx4 v50, s[48:51], s67 offen nt lds
  s_waitcnt vmcnt(0)
  ds_read_b64_tr_b16 v[164:165], v43 offset:0
  ds_read_b64_tr_b16 v[166:167], v43 offset:256
  ds_read_b64_tr_b16 v[168:169], v43 offset:32
  ds_read_b64_tr_b16 v[170:171], v43 offset:288
  ds_read_b64_tr_b16 v[172:173], v43 offset:2048
  ds_read_b64_tr_b16 v[174:175], v43 offset:2304
  ds_read_b64_tr_b16 v[176:177], v43 offset:2080
  ds_read_b64_tr_b16 v[178:179], v43 offset:2336
  s_waitcnt lgkmcnt(0)
  ds_read_b64_tr_b16 v[180:181], v43 offset:4096
  ds_read_b64_tr_b16 v[182:183], v43 offset:4352
  ds_read_b64_tr_b16 v[184:185], v43 offset:4128
  ds_read_b64_tr_b16 v[186:187], v43 offset:4384
  ds_read_b64_tr_b16 v[188:189], v43 offset:6144
  ds_read_b64_tr_b16 v[190:191], v43 offset:6400
  ds_read_b64_tr_b16 v[192:193], v43 offset:6176
  ds_read_b64_tr_b16 v[194:195], v43 offset:6432
  s_waitcnt lgkmcnt(0)
  s_waitcnt lgkmcnt(0)
  s_add_u32 m0, s65, 0
  s_add_u32 s67, s68, 2359296
  buffer_load_dwordx4 v50, s[48:51], s67 offen nt lds
  s_waitcnt vmcnt(0)
  s_add_u32 m0, s65, 1024
  s_add_u32 s67, s68, 2506752
  buffer_load_dwordx4 v50, s[48:51], s67 offen nt lds
  s_waitcnt vmcnt(0)
  ds_read_b64_tr_b16 v[196:197], v43 offset:0
  ds_read_b64_tr_b16 v[198:199], v43 offset:256
  ds_read_b64_tr_b16 v[200:201], v43 offset:32
  ds_read_b64_tr_b16 v[202:203], v43 offset:288
  s_waitcnt lgkmcnt(0)
  s_mov_b64 exec, 1
  ds_add_u32 v2, v3 offset:24
  s_mov_b64 exec, -1
  s_mov_b32 s94, 4000000
L_lw_13:
  ds_read_b32 v40, v2 offset:24
  s_waitcnt lgkmcnt(0)
  v_readfirstlane_b32 s95, v40
  s_cmp_ge_u32 s95, 4
  s_cbranch_scc1 L_lwd_14
  s_sleep 2
  s_sub_u32 s94, s94, 1
  s_cmp_lg_u32 s94, 0
  s_cbranch_scc1 L_lw_13
  s_branch L_end
L_lwd_14:
L_a_nogu:
  s_cmp_eq_u32 s39, 1
  s_cbranch_scc0 L_a_nogc
  v_lshlrev_b32 v42, 4, v1
  s_mov_b32 s64, 4784128
  s_mov_b32 s94, 400000
L_af_15:
  buffer_load_dwordx4 v[204:207], v42, s[52:55], s64 offen sc1
  buffer_load_dwordx4 v[208:211], v42, s[52:55], s64 offen offset:1024 sc1
  s_waitcnt vmcnt(0)
  v_xor_b32 v204, s92, v204
  v_xor_b32 v205, s93, v205
  v_xor_b32 v206, s92, v206
  v_xor_b32 v207, s93, v207
  v_xor_b32 v208, s92, v208
  v_xor_b32 v209, s93, v209
  v_xor_b32 v210, s92, v210
  v_xor_b32 v211, s93, v211
  v_or_b32 v204, v204, v205
  v_or_b32 v204, v204, v206
  v_or_b32 v204, v204, v207
  v_or_b32 v204, v204, v208
  v_or_b32 v204, v204, v209
  v_or_b32 v204, v204, v210
  v_or_b32 v204, v204, v211
  v_cmp_ne_u32 vcc, 0, v204
  s_cmp_eq_u64 vcc, 0
  s_cbranch_scc1 L_afd_16
  s_sleep 32
  s_sub_u32 s94, s94, 1
  s_cmp_lg_u32 s94, 0
  s_cbranch_scc1 L_af_15
  s_branch L_end
L_afd_16:
  s_mov_b64 exec, 1
  ds_add_u32 v2, v3 offset:44
  s_mov_b64 exec, -1
L_a_nogc:
  s_cmp_lt_u32 s33, 9
  s_cbranch_scc0 L_a_nowo
  s_mov_b32 s48, s12
  s_and_b32 s49, s13, 0xffff
  s_mov_b32 s50, 0x480000
  s_mov_b32 s51, 0x20000
  v_lshrrev_b32 v40, 3, v1
  v_mul_u32_u24 v40, 1152, v40
  v_and_b32 v41, 7, v1
  v_lshl_add_u32 v50, v41, 4, v40
  s_mul_i32 s68, s30, 294912
  s_lshl_b32 s64, s33, 7
  s_add_u32 s68, s68, s64
  s_mul_i32 s64, s39, 73728
  s_add_u32 s68, s68, s64
  s_lshl_b32 s65, s39, 13
  s_add_u32 s65, s65, 27904
  s_add_u32 m0, s65, 0
  s_add_u32 s67, s68, 0
  buffer_load_dwordx4 v50, s[48:51], s67 offen nt lds
  s_add_u32 m0, s65, 1024
  s_add_u32 s67, s68, 9216
  buffer_load_dwordx4 v50, s[48:51], s67 offen nt lds
  s_waitcnt vmcnt(1)
  s_add_u32 m0, s65, 2048
  s_add_u32 s67, s68, 18432
  buffer_load_dwordx4 v50, s[48:51], s67 offen nt lds
  s_waitcnt vmcnt(1)
  s_add_u32 m0, s65, 3072
  s_add_u32 s67, s68, 27648
  buffer_load_dwordx4 v50, s[48:51], s67 offen nt lds
  s_waitcnt vmcnt(1)
  s_add_u32 m0, s65, 4096
  s_add_u32 s67, s68, 36864
  buffer_load_dwordx4 v50, s[48:51], s67 offen nt lds
  s_waitcnt vmcnt(1)
  s_add_u32 m0, s65, 5120
  s_add_u32 s67, s68, 46080
  buffer_load_dwordx4 v50, s[48:51], s67 offen nt lds
  s_waitcnt vmcnt(1)
  s_add_u32 m0, s65, 6144
  s_add_u32 s67, s68, 55296
  buffer_load_dwordx4 v50, s[48:51], s67 offen nt lds
  s_waitcnt vmcnt(1)
  s_add_u32 m0, s65, 7168
  s_add_u32 s67, s68, 64512
  buffer_load_dwordx4 v50, s[48:51], s67 offen nt lds
  s_waitcnt vmcnt(0)
  s_mov_b64 exec, 1
  ds_add_u32 v2, v3 offset:28
  s_mov_b64 exec, -1
  v_lshl_add_u32 v43, v5, 7, v38
  s_lshl_b32 s64, s39, 5
  v_add_u32 v43, s64, v43
  s_mov_b32 s94, 4000000
L_lw_17:
  ds_read_b32 v40, v2 offset:28
  s_waitcnt lgkmcnt(0)
  v_readfirstlane_b32 s95, v40
  s_cmp_ge_u32 s95, 4
  s_cbranch_scc1 L_lwd_18
  s_sleep 2
  s_sub_u32 s94, s94, 1
  s_cmp_lg_u32 s94, 0
  s_cbranch_scc1 L_lw_17
  s_branch L_end
L_lwd_18:
  ds_read_b64_tr_b16 v[64:65], v43 offset:27904
  ds_read_b64_tr_b16 v[66:67], v43 offset:28416
  ds_read_b64_tr_b16 v[68:69], v43 offset:32000
  ds_read_b64_tr_b16 v[70:71], v43 offset:32512
  ds_read_b64_tr_b16 v[72:73], v43 offset:36096
  ds_read_b64_tr_b16 v[74:75], v43 offset:36608
  ds_read_b64_tr_b16 v[76:77], v43 offset:40192
  ds_read_b64_tr_b16 v[78:79], v43 offset:40704
  s_waitcnt lgkmcnt(0)
  ds_read_b64_tr_b16 v[80:81], v43 offset:44288
  ds_read_b64_tr_b16 v[82:83], v43 offset:44800
  ds_read_b64_tr_b16 v[84:85], v43 offset:48384
  ds_read_b64_tr_b16 v[86:87], v43 offset:48896
  ds_read_b64_tr_b16 v[88:89], v43 offset:52480
  ds_read_b64_tr_b16 v[90:91], v43 offset:52992
  ds_read_b64_tr_b16 v[92:93], v43 offset:56576
  ds_read_b64_tr_b16 v[94:95], v43 offset:57088
  s_waitcnt lgkmcnt(0)
  s_mov_b64 exec, 1
  ds_add_u32 v2, v3 offset:32
  s_mov_b64 exec, -1
  s_mov_b32 s94, 4000000
L_lw_19:
  ds_read_b32 v40, v2 offset:32
  s_waitcnt lgkmcnt(0)
  v_readfirstlane_b32 s95, v40
  s_cmp_ge_u32 s95, 4
  s_cbranch_scc1 L_lwd_20
  s_sleep 2
  s_sub_u32 s94, s94, 1
  s_cmp_lg_u32 s94, 0
  s_cbranch_scc1 L_lw_19
  s_branch L_end
L_lwd_20:
L_a_nowo:
  s_cmp_lt_u32 s98, 18
  s_cbranch_scc0 L_a_nowd
  s_mov_b32 s48, s20
  s_and_b32 s49, s21, 0xffff
  s_mov_b32 s50, 0x510000
  s_mov_b32 s51, 0x20000
  v_lshlrev_b32 v50, 4, v1
  s_mul_i32 s68, s34, 36864
  s_mul_i32 s64, s39, 9216
  s_add_u32 s68, s68, s64
  s_add_u32 s65, s64, 27904
  s_add_u32 m0, s65, 0
  s_add_u32 s67, s68, 0
  buffer_load_dwordx4 v50, s[48:51], s67 offen nt lds
  s_add_u32 m0, s65, 1024
  s_add_u32 s67, s68, 1024
  buffer_load_dwordx4 v50, s[48:51], s67 offen nt lds
  s_add_u32 m0, s65, 2048
  s_add_u32 s67, s68, 2048
  buffer_load_dwordx4 v50, s[48:51], s67 offen nt lds
  s_add_u32 m0, s65, 3072
  s_add_u32 s67, s68, 3072
  buffer_load_dwordx4 v50, s[48:51], s67 offen nt lds
  s_waitcnt vmcnt(3)
  s_add_u32 m0, s65, 4096
  s_add_u32 s67, s68, 4096
  buffer_load_dwordx4 v50, s[48:51], s67 offen nt lds
  s_waitcnt vmcnt(3)
  s_add_u32 m0, s65, 5120
  s_add_u32 s67, s68, 5120
  buffer_load_dwordx4 v50, s[48:51], s67 offen nt lds
  s_waitcnt vmcnt(3)
  s_add_u32 m0, s65, 6144
  s_add_u32 s67, s68, 6144
  buffer_load_dwordx4 v50, s[48:51], s67 offen nt lds
  s_waitcnt vmcnt(3)
  s_add_u32 m0, s65, 7168
  s_add_u32 s67, s68, 7168
  buffer_load_dwordx4 v50, s[48:51], s67 offen nt lds
  s_waitcnt vmcnt(3)
  s_add_u32 m0, s65, 8192
  s_add_u32 s67, s68, 8192
  buffer_load_dwordx4 v50, s[48:51], s67 offen nt lds
  s_waitcnt vmcnt(0)
  s_mov_b64 exec, 1
  ds_add_u32 v2, v3 offset:36
  s_mov_b64 exec, -1
  v_mul_u32_u24 v43, 1152, v5
  v_add_u32 v43, v43, v38
  s_mul_i32 s64, s39, 288
  v_add_u32 v43, s64, v43
  s_mov_b32 s94, 4000000
L_lw_21:
  ds_read_b32 v40, v2 offset:36
  s_waitcnt lgkmcnt(0)
  v_readfirstlane_b32 s95, v40
  s_cmp_ge_u32 s95, 4
  s_cbranch_scc1 L_lwd_22
  s_sleep 2
  s_sub_u32 s94, s94, 1
  s_cmp_lg_u32 s94, 0
  s_cbranch_scc1 L_lw_21
  s_branch L_end
L_lwd_22:
  ds_read_b64_tr_b16 v[96:97], v43 offset:27904
  ds_read_b64_tr_b16 v[98:99], v43 offset:32512
  ds_read_b64_tr_b16 v[100:101], v43 offset:27936
  ds_read_b64_tr_b16 v[102:103], v43 offset:32544
  ds_read_b64_tr_b16 v[104:105], v43 offset:27968
  ds_read_b64_tr_b16 v[106:107], v43 offset:32576
  ds_read_b64_tr_b16 v[108:109], v43 offset:28000
  ds_read_b64_tr_b16 v[110:111], v43 offset:32608
  ds_read_b64_tr_b16 v[112:113], v43 offset:28032
  ds_read_b64_tr_b16 v[114:115], v43 offset:32640
  s_waitcnt lgkmcnt(0)
  ds_read_b64_tr_b16 v[116:117], v43 offset:28064
  ds_read_b64_tr_b16 v[118:119], v43 offset:32672
  ds_read_b64_tr_b16 v[120:121], v43 offset:28096
  ds_read_b64_tr_b16 v[122:123], v43 offset:32704
  ds_read_b64_tr_b16 v[124:125], v43 offset:28128
  ds_read_b64_tr_b16 v[126:127], v43 offset:32736
  ds_read_b64_tr_b16 v[128:129], v43 offset:28160
  ds_read_b64_tr_b16 v[130:131], v43 offset:32768
  s_waitcnt lgkmcnt(0)
L_a_nowd:
L_a_tail:
  s_mov_b32 s94, 4000000
L_lw_23:
  ds_read_b32 v40, v2 offset:44
  s_waitcnt lgkmcnt(0)
  v_readfirstlane_b32 s95, v40
  s_cmp_ge_u32 s95, 1
  s_cbranch_scc1 L_lwd_24
  s_sleep 8
  s_sub_u32 s94, s94, 1
  s_cmp_lg_u32 s94, 0
  s_cbranch_scc1 L_lw_23
  s_branch L_end
L_lwd_24:
  s_mov_b32 s94, 4000000
L_lw_25:
  ds_read_b32 v40, v2 offset:20
  s_waitcnt lgkmcnt(0)
  v_readfirstlane_b32 s95, v40
  s_cmp_ge_u32 s95, 3
  s_cbranch_scc1 L_lwd_26
  s_sleep 4
  s_sub_u32 s94, s94, 1
  s_cmp_lg_u32 s94, 0
  s_cbranch_scc1 L_lw_25
  s_branch L_end
L_lwd_26:
  s_cmp_lt_u32 s33, 9
  s_cbranch_scc0 L_a_noT1
  v_lshlrev_b32 v40, 4, v1
  s_lshl_b32 s64, s30, 14
  s_lshl_b32 s67, s39, 12
  s_add_u32 s64, s64, s67
  s_add_u32 s64, s64, 131072
  s_mul_i32 s67, s39, 1056
  v_lshl_add_u32 v43, v1, 3, s67
  v_and_b32 v44, 7, v8
  v_mul_u32_u24 v44, 528, v44
  v_lshl_add_u32 v44, v7, 4, v44
  v_lshlrev_b32 v45, 6, v8
  v_lshl_add_u32 v45, v7, 4, v45
  s_mul_i32 s71, s30, 18432
  s_lshl_b32 s67, s33, 11
  s_add_u32 s71, s71, s67
  s_lshl_b32 s67, s39, 9
  s_add_u32 s71, s71, s67
  s_add_u32 s71, s71, 393216
  s_mov_b32 s94, 400000
L_t1_27:
  buffer_load_dwordx4 v[204:207], v40, s[52:55], s64 offen offset:0 sc1
  buffer_load_dwordx4 v[208:211], v40, s[52:55], s64 offen offset:1024 sc1
  buffer_load_dwordx4 v[212:215], v40, s[52:55], s64 offen offset:2048 sc1
  buffer_load_dwordx4 v[216:219], v40, s[52:55], s64 offen offset:3072 sc1
  s_waitcnt vmcnt(0)
  v_max3_u32 v41, v204, v205, v206
  v_max3_u32 v42, v212, v213, v214
  v_max3_u32 v41, v41, v207, v208
  v_max3_u32 v42, v42, v215, v216
  v_max3_u32 v41, v41, v209, v210
  v_max3_u32 v42, v42, v217, v218
  v_max_u32 v41, v41, v211
  v_max_u32 v42, v42, v219
  v_max_u32 v41, v41, v42
  v_cmp_eq_u32 vcc, -1, v41
  s_cmp_eq_u64 vcc, 0
  s_cbranch_scc1 L_t1d_28
  s_sleep 4
  s_sub_u32 s94, s94, 1
  s_cmp_lg_u32 s94, 0
  s_cbranch_scc1 L_t1_27
  s_branch L_end
L_t1d_28:
  v_pk_add_f32 v[236:237], v[204:205], v[208:209]
  v_pk_add_f32 v[238:239], v[206:207], v[210:211]
  v_pk_add_f32 v[240:241], v[212:213], v[216:217]
  v_pk_add_f32 v[242:243], v[214:215], v[218:219]
  v_cvt_pk_bf16_f32 v236, v236, v237
  v_cvt_pk_bf16_f32 v237, v238, v239
  ds_write_b64 v43, v[236:237] offset:6144
  v_cvt_pk_bf16_f32 v240, v240, v241
  v_cvt_pk_bf16_f32 v241, v242, v243
  ds_write_b64 v43, v[240:241] offset:6672
  s_waitcnt lgkmcnt(0)
  s_barrier
  ds_read_b128 v[10:13], v44 offset:6144
  ds_read_b128 v[14:17], v44 offset:6208
  ds_read_b128 v[18:21], v44 offset:6272
  ds_read_b128 v[22:25], v44 offset:6336
  ds_read_b128 v[26:29], v44 offset:6400
  ds_read_b128 v[30:33], v44 offset:6464
  ds_read_b128 v[34:37], v44 offset:6528
  ds_read_b128 v[244:247], v44 offset:6592
  s_waitcnt lgkmcnt(7)
  v_mfma_f32_16x16x32_bf16 v[56:59], v[64:67], v[10:13], 0
  s_waitcnt lgkmcnt(6)
  v_mfma_f32_16x16x32_bf16 v[60:63], v[68:71], v[14:17], 0
  s_waitcnt lgkmcnt(5)
  v_mfma_f32_16x16x32_bf16 v[56:59], v[72:75], v[18:21], v[56:59]
  s_waitcnt lgkmcnt(4)
  v_mfma_f32_16x16x32_bf16 v[60:63], v[76:79], v[22:25], v[60:63]
  s_waitcnt lgkmcnt(3)
  v_mfma_f32_16x16x32_bf16 v[56:59], v[80:83], v[26:29], v[56:59]
  s_waitcnt lgkmcnt(2)
  v_mfma_f32_16x16x32_bf16 v[60:63], v[84:87], v[30:33], v[60:63]
  s_waitcnt lgkmcnt(1)
  v_mfma_f32_16x16x32_bf16 v[56:59], v[88:91], v[34:37], v[56:59]
  s_waitcnt lgkmcnt(0)
  v_mfma_f32_16x16x32_bf16 v[60:63], v[92:95], v[244:247], v[60:63]
  s_mov_b32 exec_lo, 0xff00ff
  s_mov_b32 exec_hi, 0xff00ff
  s_nop 6
  v_pk_add_f32 v[56:57], v[56:57], v[60:61]
  v_pk_add_f32 v[58:59], v[58:59], v[62:63]
  v_min_u32 v56, -2, v56
  v_min_u32 v57, -2, v57
  v_min_u32 v58, -2, v58
  v_min_u32 v59, -2, v59
  buffer_store_dwordx4 v[56:59], v45, s[52:55], s71 offen sc1
  s_mov_b64 exec, -1
L_a_noT1:
  s_cmp_eq_u32 s39, 1
  s_cbranch_scc0 L_a_noT2
  s_cmp_ge_u32 s29, 23
  s_cbranch_scc0 L_a_noT2
  s_mul_i32 s66, s28, 9
  s_add_u32 s66, s66, s29
  s_sub_u32 s66, s66, 23
  s_mov_b32 exec_lo, 0xffffffff
  s_mov_b32 exec_hi, 0x0
  v_lshrrev_b32 v40, 3, v1
  v_mul_u32_u24 v40, 1152, v40
  v_and_b32 v41, 7, v1
  v_lshl_add_u32 v40, v41, 2, v40
  s_and_b32 s64, s66, 1
  s_mul_i32 s64, s64, 4608
  s_lshr_b32 s67, s66, 1
  s_lshl_b32 s67, s67, 5
  s_add_u32 s64, s64, s67
  buffer_load_dword v42, v40, s[60:63], s64 offen
  v_lshlrev_b32 v40, 2, v1
  v_lshlrev_b32 v41, 3, v1
  s_lshl_b32 s67, s66, 8
  s_add_u32 s67, s67, 393216
  s_lshl_b32 s71, s66, 7
  s_add_u32 s71, s71, 720896
  s_mov_b32 s94, 400000
L_t2_29:
  s_add_u32 s64, s67, 0
  buffer_load_dwordx2 v[204:205], v41, s[52:55], s64 offen sc1
  s_add_u32 s64, s67, 18432
  buffer_load_dwordx2 v[206:207], v41, s[52:55], s64 offen sc1
  s_add_u32 s64, s67, 36864
  buffer_load_dwordx2 v[208:209], v41, s[52:55], s64 offen sc1
  s_add_u32 s64, s67, 55296
  buffer_load_dwordx2 v[210:211], v41, s[52:55], s64 offen sc1
  s_add_u32 s64, s67, 73728
  buffer_load_dwordx2 v[212:213], v41, s[52:55], s64 offen sc1
  s_add_u32 s64, s67, 92160
  buffer_load_dwordx2 v[214:215], v41, s[52:55], s64 offen sc1
  s_add_u32 s64, s67, 110592
  buffer_load_dwordx2 v[216:217], v41, s[52:55], s64 offen sc1
  s_add_u32 s64, s67, 129024
  buffer_load_dwordx2 v[218:219], v41, s[52:55], s64 offen sc1
  s_add_u32 s64, s67, 147456
  buffer_load_dwordx2 v[220:221], v41, s[52:55], s64 offen sc1
  s_add_u32 s64, s67, 165888
  buffer_load_dwordx2 v[222:223], v41, s[52:55], s64 offen sc1
  s_add_u32 s64, s67, 184320
  buffer_load_dwordx2 v[224:225], v41, s[52:55], s64 offen sc1
  s_add_u32 s64, s67, 202752
  buffer_load_dwordx2 v[226:227], v41, s[52:55], s64 offen sc1
  s_add_u32 s64, s67, 221184
  buffer_load_dwordx2 v[228:229], v41, s[52:55], s64 offen sc1
  s_add_u32 s64, s67, 239616
  buffer_load_dwordx2 v[230:231], v41, s[52:55], s64 offen sc1
  s_add_u32 s64, s67, 258048
  buffer_load_dwordx2 v[232:233], v41, s[52:55], s64 offen sc1
  s_add_u32 s64, s67, 276480
  buffer_load_dwordx2 v[234:235], v41, s[52:55], s64 offen sc1
  s_waitcnt vmcnt(0)
  v_max3_u32 v43, v204, v205, v206
  v_max3_u32 v44, v220, v221, v222
  v_max3_u32 v43, v43, v207, v208
  v_max3_u32 v44, v44, v223, v224
  v_max3_u32 v43, v43, v209, v210
  v_max3_u32 v44, v44, v225, v226
  v_max3_u32 v43, v43, v211, v212
  v_max3_u32 v44, v44, v227, v228
  v_max3_u32 v43, v43, v213, v214
  v_max3_u32 v44, v44, v229, v230
  v_max3_u32 v43, v43, v215, v216
  v_max3_u32 v44, v44, v231, v232
  v_max3_u32 v43, v43, v217, v218
  v_max3_u32 v44, v44, v233, v234
  v_max_u32 v43, v43, v219
  v_max_u32 v44, v44, v235
  v_max_u32 v43, v43, v44
  v_cmp_eq_u32 vcc, -1, v43
  s_cmp_eq_u64 vcc, 0
  s_cbranch_scc1 L_t2d_30
  s_sub_u32 s94, s94, 1
  s_cmp_lg_u32 s94, 0
  s_cbranch_scc1 L_t2_29
  s_branch L_end
L_t2d_30:
  v_pk_add_f32 v[204:205], v[204:205], v[220:221]
  v_pk_add_f32 v[206:207], v[206:207], v[222:223]
  v_pk_add_f32 v[208:209], v[208:209], v[224:225]
  v_pk_add_f32 v[210:211], v[210:211], v[226:227]
  v_pk_add_f32 v[212:213], v[212:213], v[228:229]
  v_pk_add_f32 v[214:215], v[214:215], v[230:231]
  v_pk_add_f32 v[216:217], v[216:217], v[232:233]
  v_pk_add_f32 v[218:219], v[218:219], v[234:235]
  v_pk_add_f32 v[204:205], v[204:205], v[212:213]
  v_pk_add_f32 v[206:207], v[206:207], v[214:215]
  v_pk_add_f32 v[208:209], v[208:209], v[216:217]
  v_pk_add_f32 v[210:211], v[210:211], v[218:219]
  v_pk_add_f32 v[204:205], v[204:205], v[208:209]
  v_pk_add_f32 v[206:207], v[206:207], v[210:211]
  v_pk_add_f32 v[204:205], v[204:205], v[206:207]
  v_cvt_pk_bf16_f32 v43, v204, v205
  v_lshlrev_b32 v46, 16, v42
  v_and_b32 v47, 0xffff0000, v42
  v_lshlrev_b32 v44, 16, v43
  v_and_b32 v45, 0xffff0000, v43
  v_pk_add_f32 v[44:45], v[44:45], v[46:47]
  v_cvt_pk_bf16_f32 v43, v44, v45
  v_min_u32 v43, -2, v43
  buffer_store_dword v43, v40, s[52:55], s71 offen sc1
  s_add_u32 s71, s71, 0x4000
  buffer_store_dword v43, v40, s[52:55], s71 offen sc1
  s_add_u32 s71, s71, 0x4000
  buffer_store_dword v43, v40, s[52:55], s71 offen sc1
  s_add_u32 s71, s71, 0x4000
  buffer_store_dword v43, v40, s[52:55], s71 offen sc1
  s_mov_b64 exec, -1
L_a_noT2:
  s_cmp_lt_u32 s98, 18
  s_cbranch_scc0 L_a_noT3
  s_mul_i32 s64, s39, 2304
  s_add_u32 s64, s64, 720896
  s_and_b32 s67, s28, 3
  s_lshl_b32 s67, s67, 14
  s_add_u32 s64, s64, s67
  v_lshlrev_b32 v246, 4, v1
  s_mul_i32 s67, s39, 144
  v_add_u32 v40, s67, v1
  v_lshrrev_b32 v41, 4, v40
  v_bfe_u32 v42, v40, 1, 3
  v_and_b32 v43, 1, v40
  v_mul_u32_u24 v42, 1168, v42
  v_lshl_add_u32 v42, v41, 5, v42
  v_lshl_add_u32 v247, v43, 4, v42
  v_add_u32 v40, s67, v1
  v_add_u32 v40, 64, v40
  v_lshrrev_b32 v41, 4, v40
  v_bfe_u32 v42, v40, 1, 3
  v_and_b32 v43, 1, v40
  v_mul_u32_u24 v42, 1168, v42
  v_lshl_add_u32 v42, v41, 5, v42
  v_lshl_add_u32 v248, v43, 4, v42
  v_add_u32 v40, s67, v1
  v_add_u32 v40, 128, v40
  v_lshrrev_b32 v41, 4, v40
  v_bfe_u32 v42, v40, 1, 3
  v_and_b32 v43, 1, v40
  v_mul_u32_u24 v42, 1168, v42
  v_lshl_add_u32 v42, v41, 5, v42
  v_lshl_add_u32 v249, v43, 4, v42
  v_mov_b32 v212, 0
  v_mov_b32 v213, 0
  v_mov_b32 v214, 0
  v_mov_b32 v215, 0
  s_lshr_b32 s67, s39, 1
  s_mul_i32 s67, s67, 576
  v_add_u32 v240, s67, v4
  s_and_b32 s67, s39, 1
  s_lshl_b32 s67, s67, 1
  s_lshr_b32 s71, s39, 1
  s_add_u32 s67, s67, s71
  s_lshl_b32 s67, s67, 10
  v_lshlrev_b32 v241, 7, v8
  v_lshl_add_u32 v241, v7, 4, v241
  v_add_u32 v241, s67, v241
  s_lshl_b32 s67, s39, 8
  v_lshl_add_u32 v242, v1, 2, s67
  v_lshrrev_b32 v243, 1, v242
  v_and_b32 v244, 7, v8
  v_lshlrev_b32 v244, 6, v244
  v_lshl_add_u32 v244, v7, 4, v244
  v_lshlrev_b32 v245, 6, v8
  v_lshl_add_u32 v245, v7, 4, v245
  v_mov_b32 v250, v245
  s_mul_i32 s65, s34, 18432
  s_mul_i32 s67, s39, 4608
  s_add_u32 s65, s65, s67
  s_add_u32 s65, s65, 1048576
  s_mov_b32 s66, 0x3d372713
  s_mov_b32 s67, 0x3f4c422a
  s_mov_b32 s71, 0xc038aa3b
  s_waitcnt vmcnt(0)
  v_mov_b32 v88, 0
  v_mov_b32 v72, 0
  v_mov_b32 v89, 0
  v_mov_b32 v73, 0
  v_mov_b32 v90, 0
  v_mov_b32 v74, 0
  v_mov_b32 v91, 0
  v_mov_b32 v75, 0
  s_mov_b64 exec, 1
  s_mov_b32 s94, 400000
L_t3p_31:
  buffer_load_dword v64, v246, s[52:55], s64 offen sc1
  s_waitcnt vmcnt(0)
  v_cmp_eq_u32 vcc, -1, v64
  s_cmp_eq_u64 vcc, 0
  s_cbranch_scc1 L_t3pd_32
  s_sleep 2
  s_sub_u32 s94, s94, 1
  s_cmp_lg_u32 s94, 0
  s_cbranch_scc1 L_t3p_31
  s_branch L_end
L_t3pd_32:
  s_mov_b64 exec, -1
  s_mov_b32 s94, 400000
L_t3_33:
  buffer_load_dwordx4 v[80:83], v246, s[52:55], s64 offen sc1
  buffer_load_dwordx4 v[84:87], v246, s[52:55], s64 offen offset:1024 sc1
  s_mov_b64 exec, 0xffff
  buffer_load_dwordx4 v[88:91], v246, s[52:55], s64 offen offset:2048 sc1
  s_mov_b64 exec, -1
  s_waitcnt vmcnt(0)
  v_max3_u32 v40, v80, v81, v82
  v_max3_u32 v41, v86, v87, v88
  v_max3_u32 v40, v40, v83, v84
  v_max3_u32 v41, v41, v89, v90
  v_max_u32 v40, v40, v85
  v_max_u32 v41, v41, v91
  v_max_u32 v40, v40, v41
  v_cmp_eq_u32 vcc, -1, v40
  s_cmp_eq_u64 vcc, 0
  s_cbranch_scc1 L_t3d_34
  s_sub_u32 s94, s94, 1
  s_cmp_lg_u32 s94, 0
  s_cbranch_scc1 L_t3_33
  s_branch L_end
L_t3d_34:
  ds_write_b128 v247, v[80:83] offset:10368
  ds_write_b128 v248, v[84:87] offset:10368
  s_mov_b64 exec, 0xffff
  ds_write_b128 v249, v[88:91] offset:10368
  s_mov_b64 exec, -1
  s_waitcnt lgkmcnt(0)
  s_barrier
  ds_read_b32 v10, v6 offset:10368
  ds_read_b32 v11, v6 offset:10496
  ds_read_b32 v12, v6 offset:10624
  ds_read_b32 v13, v6 offset:10752
  ds_read_b32 v14, v6 offset:10880
  ds_read_b32 v15, v6 offset:11008
  ds_read_b32 v16, v6 offset:11136
  ds_read_b32 v17, v6 offset:11264
  ds_read_b32 v18, v6 offset:11392
  s_waitcnt lgkmcnt(0)
  v_lshlrev_b32 v20, 16, v10
  v_and_b32 v21, 0xffff0000, v10
  v_lshlrev_b32 v22, 16, v11
  v_and_b32 v23, 0xffff0000, v11
  v_lshlrev_b32 v24, 16, v12
  v_and_b32 v25, 0xffff0000, v12
  v_lshlrev_b32 v26, 16, v13
  v_and_b32 v27, 0xffff0000, v13
  v_lshlrev_b32 v28, 16, v14
  v_and_b32 v29, 0xffff0000, v14
  v_lshlrev_b32 v30, 16, v15
  v_and_b32 v31, 0xffff0000, v15
  v_lshlrev_b32 v32, 16, v16
  v_and_b32 v33, 0xffff0000, v16
  v_lshlrev_b32 v34, 16, v17
  v_and_b32 v35, 0xffff0000, v17
  v_lshlrev_b32 v36, 16, v18
  v_and_b32 v37, 0xffff0000, v18
  v_pk_add_f32 v[40:41], v[20:21], v[22:23]
  v_pk_add_f32 v[42:43], v[24:25], v[26:27]
  v_pk_add_f32 v[44:45], v[28:29], v[30:31]
  v_pk_add_f32 v[46:47], v[32:33], v[34:35]
  v_pk_add_f32 v[40:41], v[40:41], v[36:37]
  v_pk_add_f32 v[42:43], v[42:43], v[44:45]
  v_pk_add_f32 v[40:41], v[40:41], v[46:47]
  v_pk_add_f32 v[40:41], v[40:41], v[42:43]
  v_add_f32 v40, v40, v41
  s_nop 1
  v_add_f32_dpp v40, v40, v40 quad_perm:[1,0,3,2] row_mask:0xf bank_mask:0xf
  s_nop 1
  v_add_f32_dpp v40, v40, v40 quad_perm:[2,3,0,1] row_mask:0xf bank_mask:0xf
  s_nop 1
  v_add_f32_dpp v40, v40, v40 row_half_mirror row_mask:0xf bank_mask:0xf
  s_nop 1
  v_add_f32_dpp v40, v40, v40 row_mirror row_mask:0xf bank_mask:0xf
  v_mov_b32 v41, v40
  s_nop 1
  v_permlane16_swap_b32 v40, v41
  s_nop 1
  v_add_f32 v40, v40, v41
  v_mul_f32 v40, 0x3ae38e39, v40
  v_mov_b32 v41, v40
  v_pk_add_f32 v[44:45], v[20:21], v[40:41] neg_lo:[0,1] neg_hi:[0,1]
  v_pk_mul_f32 v[50:51], v[44:45], v[44:45]
  v_pk_add_f32 v[46:47], v[22:23], v[40:41] neg_lo:[0,1] neg_hi:[0,1]
  v_pk_mul_f32 v[52:53], v[46:47], v[46:47]
  v_pk_add_f32 v[48:49], v[24:25], v[40:41] neg_lo:[0,1] neg_hi:[0,1]
  v_pk_mul_f32 v[54:55], v[48:49], v[48:49]
  v_pk_add_f32 v[44:45], v[26:27], v[40:41] neg_lo:[0,1] neg_hi:[0,1]
  v_pk_fma_f32 v[50:51], v[44:45], v[44:45], v[50:51]
  v_pk_add_f32 v[46:47], v[28:29], v[40:41] neg_lo:[0,1] neg_hi:[0,1]
  v_pk_fma_f32 v[52:53], v[46:47], v[46:47], v[52:53]
  v_pk_add_f32 v[48:49], v[30:31], v[40:41] neg_lo:[0,1] neg_hi:[0,1]
  v_pk_fma_f32 v[54:55], v[48:49], v[48:49], v[54:55]
  v_pk_add_f32 v[44:45], v[32:33], v[40:41] neg_lo:[0,1] neg_hi:[0,1]
  v_pk_fma_f32 v[50:51], v[44:45], v[44:45], v[50:51]
  v_pk_add_f32 v[46:47], v[34:35], v[40:41] neg_lo:[0,1] neg_hi:[0,1]
  v_pk_fma_f32 v[52:53], v[46:47], v[46:47], v[52:53]
  v_pk_add_f32 v[48:49], v[36:37], v[40:41] neg_lo:[0,1] neg_hi:[0,1]
  v_pk_fma_f32 v[54:55], v[48:49], v[48:49], v[54:55]
  v_pk_add_f32 v[50:51], v[50:51], v[52:53]
  v_pk_add_f32 v[50:51], v[50:51], v[54:55]
  v_add_f32 v42, v50, v51
  s_nop 1
  v_add_f32_dpp v42, v42, v42 quad_perm:[1,0,3,2] row_mask:0xf bank_mask:0xf
  s_nop 1
  v_add_f32_dpp v42, v42, v42 quad_perm:[2,3,0,1] row_mask:0xf bank_mask:0xf
  s_nop 1
  v_add_f32_dpp v42, v42, v42 row_half_mirror row_mask:0xf bank_mask:0xf
  s_nop 1
  v_add_f32_dpp v42, v42, v42 row_mirror row_mask:0xf bank_mask:0xf
  v_mov_b32 v43, v42
  s_nop 1
  v_permlane16_swap_b32 v42, v43
  s_nop 1
  v_add_f32 v42, v42, v43
  v_mul_f32 v42, 0x3ae38e39, v42
  v_cvt_pk_bf16_f32 v43, v40, v42
  v_lshlrev_b32 v44, 16, v43
  v_and_b32 v46, 0xffff0000, v43
  v_mov_b32 v45, v44
  v_add_f32 v46, 0x3727c5ac, v46
  v_cvt_pk_bf16_f32 v46, v46, v46
  v_lshlrev_b32 v46, 16, v46
  v_sqrt_f32 v46, v46
  v_pk_add_f32 v[20:21], v[20:21], v[44:45] neg_lo:[0,1] neg_hi:[0,1]
  v_pk_add_f32 v[22:23], v[22:23], v[44:45] neg_lo:[0,1] neg_hi:[0,1]
  v_pk_add_f32 v[24:25], v[24:25], v[44:45] neg_lo:[0,1] neg_hi:[0,1]
  v_pk_add_f32 v[26:27], v[26:27], v[44:45] neg_lo:[0,1] neg_hi:[0,1]
  v_pk_add_f32 v[28:29], v[28:29], v[44:45] neg_lo:[0,1] neg_hi:[0,1]
  v_pk_add_f32 v[30:31], v[30:31], v[44:45] neg_lo:[0,1] neg_hi:[0,1]
  v_pk_add_f32 v[32:33], v[32:33], v[44:45] neg_lo:[0,1] neg_hi:[0,1]
  v_pk_add_f32 v[34:35], v[34:35], v[44:45] neg_lo:[0,1] neg_hi:[0,1]
  v_pk_add_f32 v[36:37], v[36:37], v[44:45] neg_lo:[0,1] neg_hi:[0,1]
  v_cvt_pk_bf16_f32 v46, v46, v46
  v_lshlrev_b32 v46, 16, v46
  v_rcp_f32 v46, v46
  v_cvt_pk_bf16_f32 v10, v20, v21
  v_cvt_pk_bf16_f32 v11, v22, v23
  v_cvt_pk_bf16_f32 v12, v24, v25
  v_cvt_pk_bf16_f32 v13, v26, v27
  v_cvt_pk_bf16_f32 v14, v28, v29
  v_cvt_pk_bf16_f32 v15, v30, v31
  v_cvt_pk_bf16_f32 v16, v32, v33
  v_cvt_pk_bf16_f32 v17, v34, v35
  v_cvt_pk_bf16_f32 v18, v36, v37
  v_mov_b32 v47, v46
  v_lshlrev_b32 v20, 16, v10
  v_and_b32 v21, 0xffff0000, v10
  v_lshlrev_b32 v22, 16, v11
  v_and_b32 v23, 0xffff0000, v11
  v_lshlrev_b32 v24, 16, v12
  v_and_b32 v25, 0xffff0000, v12
  v_lshlrev_b32 v26, 16, v13
  v_and_b32 v27, 0xffff0000, v13
  v_lshlrev_b32 v28, 16, v14
  v_and_b32 v29, 0xffff0000, v14
  v_lshlrev_b32 v30, 16, v15
  v_and_b32 v31, 0xffff0000, v15
  v_lshlrev_b32 v32, 16, v16
  v_and_b32 v33, 0xffff0000, v16
  v_lshlrev_b32 v34, 16, v17
  v_and_b32 v35, 0xffff0000, v17
  v_lshlrev_b32 v36, 16, v18
  v_and_b32 v37, 0xffff0000, v18
  v_pk_mul_f32 v[20:21], v[20:21], v[46:47]
  v_pk_mul_f32 v[22:23], v[22:23], v[46:47]
  v_pk_mul_f32 v[24:25], v[24:25], v[46:47]
  v_pk_mul_f32 v[26:27], v[26:27], v[46:47]
  v_pk_mul_f32 v[28:29], v[28:29], v[46:47]
  v_pk_mul_f32 v[30:31], v[30:31], v[46:47]
  v_pk_mul_f32 v[32:33], v[32:33], v[46:47]
  v_pk_mul_f32 v[34:35], v[34:35], v[46:47]
  v_pk_mul_f32 v[36:37], v[36:37], v[46:47]
  v_cvt_pk_bf16_f32 v10, v20, v21
  ds_write_b32 v6, v10 offset:10368
  v_cvt_pk_bf16_f32 v11, v22, v23
  ds_write_b32 v6, v11 offset:10496
  v_cvt_pk_bf16_f32 v12, v24, v25
  ds_write_b32 v6, v12 offset:10624
  v_cvt_pk_bf16_f32 v13, v26, v27
  ds_write_b32 v6, v13 offset:10752
  v_cvt_pk_bf16_f32 v14, v28, v29
  ds_write_b32 v6, v14 offset:10880
  v_cvt_pk_bf16_f32 v15, v30, v31
  ds_write_b32 v6, v15 offset:11008
  v_cvt_pk_bf16_f32 v16, v32, v33
  ds_write_b32 v6, v16 offset:11136
  v_cvt_pk_bf16_f32 v17, v34, v35
  ds_write_b32 v6, v17 offset:11264
  v_cvt_pk_bf16_f32 v18, v36, v37
  ds_write_b32 v6, v18 offset:11392
  s_waitcnt lgkmcnt(0)
  s_barrier
  ds_read_b128 v[204:207], v240 offset:10368
  ds_read_b128 v[208:211], v240 offset:10432
  ds_read_b128 v[212:215], v240 offset:10496
  ds_read_b128 v[216:219], v240 offset:10560
  ds_read_b128 v[220:223], v240 offset:10624
  ds_read_b128 v[224:227], v240 offset:10688
  ds_read_b128 v[228:231], v240 offset:10752
  ds_read_b128 v[232:235], v240 offset:10816
  ds_read_b128 v[236:239], v240 offset:10880
  s_waitcnt lgkmcnt(8)
  v_mfma_f32_16x16x32_bf16 v[56:59], v[132:135], v[204:207], 0
  v_mfma_f32_16x16x32_bf16 v[60:63], v[136:139], v[204:207], 0
  s_waitcnt lgkmcnt(7)
  v_mfma_f32_16x16x32_bf16 v[56:59], v[140:143], v[208:211], v[56:59]
  v_mfma_f32_16x16x32_bf16 v[60:63], v[144:147], v[208:211], v[60:63]
  s_waitcnt lgkmcnt(6)
  v_mfma_f32_16x16x32_bf16 v[56:59], v[148:151], v[212:215], v[56:59]
  v_mfma_f32_16x16x32_bf16 v[60:63], v[152:155], v[212:215], v[60:63]
  s_waitcnt lgkmcnt(5)
  v_mfma_f32_16x16x32_bf16 v[56:59], v[156:159], v[216:219], v[56:59]
  v_mfma_f32_16x16x32_bf16 v[60:63], v[160:163], v[216:219], v[60:63]
  s_waitcnt lgkmcnt(4)
  v_mfma_f32_16x16x32_bf16 v[56:59], v[164:167], v[220:223], v[56:59]
  v_mfma_f32_16x16x32_bf16 v[60:63], v[168:171], v[220:223], v[60:63]
  s_waitcnt lgkmcnt(3)
  v_mfma_f32_16x16x32_bf16 v[56:59], v[172:175], v[224:227], v[56:59]
  v_mfma_f32_16x16x32_bf16 v[60:63], v[176:179], v[224:227], v[60:63]
  s_waitcnt lgkmcnt(2)
  v_mfma_f32_16x16x32_bf16 v[56:59], v[180:183], v[228:231], v[56:59]
  v_mfma_f32_16x16x32_bf16 v[60:63], v[184:187], v[228:231], v[60:63]
  s_waitcnt lgkmcnt(1)
  v_mfma_f32_16x16x32_bf16 v[56:59], v[188:191], v[232:235], v[56:59]
  v_mfma_f32_16x16x32_bf16 v[60:63], v[192:195], v[232:235], v[60:63]
  s_waitcnt lgkmcnt(0)
  v_mfma_f32_16x16x32_bf16 v[56:59], v[196:199], v[236:239], v[56:59]
  v_mfma_f32_16x16x32_bf16 v[60:63], v[200:203], v[236:239], v[60:63]
  s_mov_b32 exec_lo, 0xff00ff
  s_mov_b32 exec_hi, 0xff00ff
  s_nop 5
  ds_write_b128 v241, v[56:59] offset:2048
  ds_write_b128 v241, v[60:63] offset:2112
  s_mov_b64 exec, -1
  s_waitcnt lgkmcnt(0)
  s_barrier
  ds_read_b32 v40, v242 offset:2048
  ds_read_b32 v41, v242 offset:3072
  ds_read_b32 v42, v242 offset:4096
  ds_read_b32 v43, v242 offset:5120
  s_waitcnt lgkmcnt(0)
  v_add_f32 v40, v40, v41
  v_add_f32 v42, v42, v43
  v_cvt_pk_bf16_f32 v44, v40, v42
  v_lshlrev_b32 v40, 16, v44
  v_and_b32 v42, 0xffff0000, v44
  v_mul_f32 v45, v40, v40
  v_mul_f32 v45, v45, v40
  v_fma_f32 v45, v45, s66, v40
  v_mul_f32 v45, s67, v45
  v_mul_f32 v45, s71, v45
  v_exp_f32 v45, v45
  v_mul_f32 v40, 0.5, v40
  v_add_f32 v45, 1.0, v45
  v_rcp_f32 v45, v45
  s_nop 0
  v_add_f32 v45, v45, v45
  v_subrev_f32 v45, 1.0, v45
  v_add_f32 v45, 1.0, v45
  v_mul_f32 v40, v40, v45
  v_cvt_pk_bf16_f32 v44, v40, v40
  v_lshlrev_b32 v40, 16, v44
  v_mul_f32 v40, v40, v42
  v_cvt_pk_bf16_f32 v44, v40, v40
  ds_write_b16 v243, v44 offset:1024
  s_waitcnt lgkmcnt(0)
  s_barrier
  ds_read_b128 v[40:43], v244 offset:1024
  s_waitcnt lgkmcnt(0)
  v_mfma_f32_16x16x32_bf16 v[204:207], v[96:99], v[40:43], 0
  v_mfma_f32_16x16x32_bf16 v[208:211], v[100:103], v[40:43], 0
  v_mfma_f32_16x16x32_bf16 v[212:215], v[104:107], v[40:43], 0
  v_mfma_f32_16x16x32_bf16 v[216:219], v[108:111], v[40:43], 0
  v_mfma_f32_16x16x32_bf16 v[220:223], v[112:115], v[40:43], 0
  v_mfma_f32_16x16x32_bf16 v[224:227], v[116:119], v[40:43], 0
  v_mfma_f32_16x16x32_bf16 v[228:231], v[120:123], v[40:43], 0
  v_mfma_f32_16x16x32_bf16 v[232:235], v[124:127], v[40:43], 0
  v_mfma_f32_16x16x32_bf16 v[236:239], v[128:131], v[40:43], 0
  s_nop 1
  v_mov_b32_dpp v204, v208 row_shr:8 row_mask:0xf bank_mask:0xc
  v_mov_b32_dpp v205, v209 row_shr:8 row_mask:0xf bank_mask:0xc
  v_mov_b32_dpp v206, v210 row_shr:8 row_mask:0xf bank_mask:0xc
  v_mov_b32_dpp v207, v211 row_shr:8 row_mask:0xf bank_mask:0xc
  v_min_u32 v204, -2, v204
  v_min_u32 v205, -2, v205
  v_min_u32 v206, -2, v206
  v_min_u32 v207, -2, v207
  buffer_store_dwordx4 v[204:207], v250, s[52:55], s65 offen offset:0 sc1
  v_mov_b32_dpp v212, v216 row_shr:8 row_mask:0xf bank_mask:0xc
  v_mov_b32_dpp v213, v217 row_shr:8 row_mask:0xf bank_mask:0xc
  v_mov_b32_dpp v214, v218 row_shr:8 row_mask:0xf bank_mask:0xc
  v_mov_b32_dpp v215, v219 row_shr:8 row_mask:0xf bank_mask:0xc
  v_min_u32 v212, -2, v212
  v_min_u32 v213, -2, v213
  v_min_u32 v214, -2, v214
  v_min_u32 v215, -2, v215
  buffer_store_dwordx4 v[212:215], v250, s[52:55], s65 offen offset:1024 sc1
  v_mov_b32_dpp v220, v224 row_shr:8 row_mask:0xf bank_mask:0xc
  v_mov_b32_dpp v221, v225 row_shr:8 row_mask:0xf bank_mask:0xc
  v_mov_b32_dpp v222, v226 row_shr:8 row_mask:0xf bank_mask:0xc
  v_mov_b32_dpp v223, v227 row_shr:8 row_mask:0xf bank_mask:0xc
  v_min_u32 v220, -2, v220
  v_min_u32 v221, -2, v221
  v_min_u32 v222, -2, v222
  v_min_u32 v223, -2, v223
  buffer_store_dwordx4 v[220:223], v250, s[52:55], s65 offen offset:2048 sc1
  v_mov_b32_dpp v228, v232 row_shr:8 row_mask:0xf bank_mask:0xc
  v_mov_b32_dpp v229, v233 row_shr:8 row_mask:0xf bank_mask:0xc
  v_mov_b32_dpp v230, v234 row_shr:8 row_mask:0xf bank_mask:0xc
  v_mov_b32_dpp v231, v235 row_shr:8 row_mask:0xf bank_mask:0xc
  v_min_u32 v228, -2, v228
  v_min_u32 v229, -2, v229
  v_min_u32 v230, -2, v230
  v_min_u32 v231, -2, v231
  buffer_store_dwordx4 v[228:231], v250, s[52:55], s65 offen offset:3072 sc1
  s_mov_b32 exec_lo, 0xff00ff
  s_mov_b32 exec_hi, 0xff00ff
  v_min_u32 v236, -2, v236
  v_min_u32 v237, -2, v237
  v_min_u32 v238, -2, v238
  v_min_u32 v239, -2, v239
  s_add_u32 s65, s65, 4096
  buffer_store_dwordx4 v[236:239], v245, s[52:55], s65 offen sc1
  s_mov_b64 exec, -1
L_a_noT3:
  s_cmp_lt_u32 s98, 18
  s_cbranch_scc0 L_fin
  s_mov_b32 s66, s34
  v_and_b32 v40, 7, v1
  v_lshlrev_b32 v41, 3, v40
  v_lshrrev_b32 v42, 3, v1
  v_mul_u32_u24 v42, 18432, v42
  v_lshl_add_u32 v42, v40, 4, v42
  s_lshl_b32 s71, s66, 6
  s_add_u32 s71, s71, 720896
  s_and_b32 s67, s28, 3
  s_lshl_b32 s67, s67, 14
  s_add_u32 s71, s71, s67
  v_bfe_u32 v45, v1, 2, 1
  v_mul_u32_u24 v45, 1152, v45
  v_and_b32 v46, 3, v1
  v_lshl_add_u32 v45, v46, 3, v45
  s_and_b32 s67, s66, 3
  s_mul_i32 s67, s67, 2304
  s_lshr_b32 s64, s66, 2
  s_lshl_b32 s64, s64, 5
  s_add_u32 s67, s67, s64
  s_mov_b32 s48, s22
  s_and_b32 s49, s23, 0xffff
  s_mov_b32 s50, 0x2400
  s_mov_b32 s51, 0x20000
  s_lshl_b32 s64, s39, 7
  v_lshl_add_u32 v46, v40, 4, s64
  v_lshlrev_b32 v47, 4, v40
  v_mov_b32 v80, 0
  v_mov_b32 v81, 0
  v_mov_b32 v82, 0
  v_mov_b32 v83, 0
  buffer_load_dwordx2 v[48:49], v41, s[52:55], s71 offen sc1
  s_lshl_b32 s71, s66, 7
  s_mul_i32 s64, s39, 663552
  s_add_u32 s71, s71, s64
  s_add_u32 s71, s71, 1048576
  v_mov_b32 v144, 0
  v_mov_b32 v176, 0
  v_mov_b32 v145, 0
  v_mov_b32 v177, 0
  v_mov_b32 v146, 0
  v_mov_b32 v178, 0
  v_mov_b32 v147, 0
  v_mov_b32 v179, 0
  s_mov_b32 s94, 400000
L_t4g_35:
  s_add_u32 s64, s71, 0
  buffer_load_dwordx4 v[128:131], v42, s[52:55], s64 offen sc1
  s_add_u32 s64, s71, 147456
  buffer_load_dwordx4 v[132:135], v42, s[52:55], s64 offen sc1
  s_add_u32 s64, s71, 294912
  buffer_load_dwordx4 v[136:139], v42, s[52:55], s64 offen sc1
  s_add_u32 s64, s71, 442368
  buffer_load_dwordx4 v[140:143], v42, s[52:55], s64 offen sc1
  s_add_u32 s64, s71, 589824
  s_mov_b32 exec_lo, 0xffffffff
  s_mov_b32 exec_hi, 0x0
  buffer_load_dwordx4 v[144:147], v42, s[52:55], s64 offen sc1
  s_mov_b64 exec, -1
  s_waitcnt vmcnt(0)
  v_max3_u32 v43, v128, v129, v130
  v_max3_u32 v44, v138, v139, v140
  v_max3_u32 v43, v43, v131, v132
  v_max3_u32 v44, v44, v141, v142
  v_max3_u32 v43, v43, v133, v134
  v_max3_u32 v44, v44, v143, v144
  v_max3_u32 v43, v43, v135, v136
  v_max3_u32 v44, v44, v145, v146
  v_max_u32 v43, v43, v137
  v_max_u32 v44, v44, v147
  v_max_u32 v43, v43, v44
  v_cmp_eq_u32 vcc, -1, v43
  s_cmp_eq_u64 vcc, 0
  s_cbranch_scc1 L_t4gd_36
  s_sub_u32 s94, s94, 1
  s_cmp_lg_u32 s94, 0
  s_cbranch_scc1 L_t4g_35
  s_branch L_end
L_t4gd_36:
  v_pk_add_f32 v[64:65], v[128:129], v[132:133]
  v_pk_add_f32 v[68:69], v[136:137], v[140:141]
  v_pk_add_f32 v[66:67], v[130:131], v[134:135]
  v_pk_add_f32 v[70:71], v[138:139], v[142:143]
  v_pk_add_f32 v[64:65], v[64:65], v[144:145]
  v_pk_add_f32 v[66:67], v[66:67], v[146:147]
  v_pk_add_f32 v[64:65], v[64:65], v[68:69]
  v_pk_add_f32 v[66:67], v[66:67], v[70:71]
  s_nop 1
  v_add_f32_dpp v64, v64, v64 row_ror:8 row_mask:0xf bank_mask:0xf
  v_add_f32_dpp v65, v65, v65 row_ror:8 row_mask:0xf bank_mask:0xf
  v_add_f32_dpp v66, v66, v66 row_ror:8 row_mask:0xf bank_mask:0xf
  v_add_f32_dpp v67, v67, v67 row_ror:8 row_mask:0xf bank_mask:0xf
  v_mov_b32 v68, v64
  v_mov_b32 v69, v65
  v_mov_b32 v70, v66
  v_mov_b32 v71, v67
  s_nop 1
  v_permlane16_swap_b32 v64, v68
  v_permlane16_swap_b32 v65, v69
  v_permlane16_swap_b32 v66, v70
  v_permlane16_swap_b32 v67, v71
  s_nop 1
  v_pk_add_f32 v[64:65], v[64:65], v[68:69]
  v_pk_add_f32 v[66:67], v[66:67], v[70:71]
  v_mov_b32 v68, v64
  v_mov_b32 v69, v65
  v_mov_b32 v70, v66
  v_mov_b32 v71, v67
  s_nop 1
  v_permlane32_swap_b32 v64, v68
  v_permlane32_swap_b32 v65, v69
  v_permlane32_swap_b32 v66, v70
  v_permlane32_swap_b32 v67, v71
  s_nop 1
  v_pk_add_f32 v[64:65], v[64:65], v[68:69]
  v_pk_add_f32 v[66:67], v[66:67], v[70:71]
  s_mov_b64 exec, 0xff
  ds_write_b128 v46, v[64:67] offset:6144
  s_mov_b64 exec, -1
  s_waitcnt lgkmcnt(0)
  s_barrier
  s_cmp_eq_u32 s39, 2
  s_cbranch_scc0 L_fin
  ds_read_b128 v[64:67], v47 offset:6144
  ds_read_b128 v[68:71], v47 offset:6272
  ds_read_b128 v[72:75], v47 offset:6400
  ds_read_b128 v[76:79], v47 offset:6528
  v_lshlrev_b32 v84, 16, v48
  v_and_b32 v85, 0xffff0000, v48
  v_lshlrev_b32 v86, 16, v49
  v_and_b32 v87, 0xffff0000, v49
  s_waitcnt lgkmcnt(0)
  v_pk_add_f32 v[64:65], v[64:65], v[68:69]
  v_pk_add_f32 v[66:67], v[66:67], v[70:71]
  v_pk_add_f32 v[72:73], v[72:73], v[76:77]
  v_pk_add_f32 v[74:75], v[74:75], v[78:79]
  v_pk_add_f32 v[64:65], v[64:65], v[72:73]
  v_pk_add_f32 v[66:67], v[66:67], v[74:75]
  v_cvt_pk_bf16_f32 v68, v64, v65
  v_cvt_pk_bf16_f32 v69, v66, v67
  v_lshlrev_b32 v64, 16, v68
  v_and_b32 v65, 0xffff0000, v68
  v_lshlrev_b32 v66, 16, v69
  v_and_b32 v67, 0xffff0000, v69
  v_pk_add_f32 v[64:65], v[64:65], v[84:85]
  v_pk_add_f32 v[66:67], v[66:67], v[86:87]
  v_cvt_pk_bf16_f32 v68, v64, v65
  v_cvt_pk_bf16_f32 v69, v66, v67
  s_mov_b64 exec, 0xff
  buffer_store_dwordx2 v[68:69], v45, s[48:51], s67 offen
  s_mov_b64 exec, -1
  s_branch L_fin
L_stream:
  s_mul_i32 s65, s3, 24576
  s_add_u32 s65, s65, 64768
  s_lshl_b32 s66, s31, 4
  s_add_u32 s66, s66, s30
  s_lshl_b32 s66, s66, 20
  s_lshl_b32 s64, s32, 19
  s_add_u32 s66, s66, s64
  s_lshl_b32 s64, s3, 12
  s_add_u32 s66, s66, s64
  v_lshlrev_b32 v232, 1, v7
  v_xor_b32 v233, v232, v8
  v_lshlrev_b32 v234, 8, v7
  v_lshl_add_u32 v5, v233, 4, v234
  v_xor_b32 v233, 8, v233
  v_lshl_add_u32 v6, v233, 4, v234
  v_lshlrev_b32 v232, 8, v8
  v_lshl_add_u32 v9, v7, 4, v232
  s_waitcnt lgkmcnt(0)
  s_mov_b32 s40, s6
  s_and_b32 s41, s7, 0xffff
  s_mov_b32 s42, 0x8000000
  s_mov_b32 s43, 0x20000
  s_mov_b32 s44, s8
  s_and_b32 s45, s9, 0xffff
  s_mov_b32 s46, 0x8000000
  s_mov_b32 s47, 0x20000
  s_mov_b32 s52, s26
  s_and_b32 s53, s27, 0xffff
  s_mov_b32 s54, 0x20000000
  s_mov_b32 s55, 0x20000
  s_add_u32 m0, s65, 0
  s_add_u32 s67, s66, 0
  buffer_load_dwordx4 v5, s[40:43], s67 offen offset:0 nt lds
  buffer_load_dwordx4 v5, s[40:43], s67 offen offset:1024 nt lds
  buffer_load_dwordx4 v6, s[40:43], s67 offen offset:2048 nt lds
  buffer_load_dwordx4 v6, s[40:43], s67 offen offset:3072 nt lds
  s_add_u32 m0, s65, 4096
  s_add_u32 s67, s66, 16384
  buffer_load_dwordx4 v5, s[40:43], s67 offen offset:0 nt lds
  s_barrier
  v_and_b32 v232, 3, v8
  v_lshrrev_b32 v233, 3, v8
  v_lshl_add_u32 v232, v233, 2, v232
  v_lshlrev_b32 v232, 1, v232
  v_lshlrev_b32 v234, 8, v8
  v_add_u32 v234, s65, v234
  v_add_u32 v233, 0, v7
  v_xor_b32 v233, v233, v232
  v_lshl_add_u32 v10, v233, 4, v234
  v_add_u32 v233, 4, v7
  v_xor_b32 v233, v233, v232
  v_lshl_add_u32 v11, v233, 4, v234
  v_add_u32 v233, 8, v7
  v_xor_b32 v233, v233, v232
  v_lshl_add_u32 v12, v233, 4, v234
  v_add_u32 v233, 12, v7
  v_xor_b32 v233, v233, v232
  v_lshl_add_u32 v13, v233, 4, v234
  v_bfe_u32 v232, v1, 2, 2
  v_and_b32 v233, 1, v7
  v_lshl_add_u32 v235, v233, 2, v232
  v_lshl_add_u32 v236, v233, 3, v232
  v_lshlrev_b32 v236, 8, v236
  v_lshrrev_b32 v237, 1, v7
  v_lshl_add_u32 v236, v237, 12, v236
  v_and_b32 v237, 3, v1
  v_lshl_add_u32 v236, v237, 3, v236
  v_add_u32 v236, s65, v236
  v_xor_b32 v237, 0, v235
  v_lshl_add_u32 v14, v237, 5, v236
  v_add_u32 v15, 1024, v14
  v_xor_b32 v237, 1, v235
  v_lshl_add_u32 v16, v237, 5, v236
  v_add_u32 v17, 1024, v16
  v_xor_b32 v237, 2, v235
  v_lshl_add_u32 v18, v237, 5, v236
  v_add_u32 v19, 1024, v18
  v_xor_b32 v237, 3, v235
  v_lshl_add_u32 v20, v237, 5, v236
  v_add_u32 v21, 1024, v20
  v_xor_b32 v237, 4, v235
  v_lshl_add_u32 v22, v237, 5, v236
  v_add_u32 v23, 1024, v22
  v_xor_b32 v237, 5, v235
  v_lshl_add_u32 v24, v237, 5, v236
  v_add_u32 v25, 1024, v24
  v_xor_b32 v237, 6, v235
  v_lshl_add_u32 v26, v237, 5, v236
  v_add_u32 v27, 1024, v26
  v_xor_b32 v237, 7, v235
  v_lshl_add_u32 v28, v237, 5, v236
  v_add_u32 v29, 1024, v28
  s_mul_i32 s64, s3, 2048
  s_add_u32 s64, s64, 19712
  v_and_b32 v232, 1, v8
  v_mul_u32_u24 v233, 1024, v232
  v_lshl_add_u32 v233, v7, 4, v233
  v_add_u32 v30, s64, v233
  s_mov_b32 s69, 0x3db504f3
  s_mov_b32 s70, 0x3fb8aa3b
  v_mov_b32 v128, 0
  v_mov_b32 v129, 0
  v_mov_b32 v130, 0
  v_mov_b32 v131, 0
  v_mov_b32 v132, 0
  v_mov_b32 v133, 0
  v_mov_b32 v134, 0
  v_mov_b32 v135, 0
  v_mov_b32 v136, 0
  v_mov_b32 v137, 0
  v_mov_b32 v138, 0
  v_mov_b32 v139, 0
  v_mov_b32 v140, 0
  v_mov_b32 v141, 0
  v_mov_b32 v142, 0
  v_mov_b32 v143, 0
  v_mov_b32 v144, 0
  v_mov_b32 v145, 0
  v_mov_b32 v146, 0
  v_mov_b32 v147, 0
  v_mov_b32 v148, 0
  v_mov_b32 v149, 0
  v_mov_b32 v150, 0
  v_mov_b32 v151, 0
  v_mov_b32 v152, 0
  v_mov_b32 v153, 0
  v_mov_b32 v154, 0
  v_mov_b32 v155, 0
  v_mov_b32 v156, 0
  v_mov_b32 v157, 0
  v_mov_b32 v158, 0
  v_mov_b32 v159, 0
  v_mov_b32 v160, 0
  v_mov_b32 v161, 0
  v_mov_b32 v162, 0
  v_mov_b32 v163, 0
  v_mov_b32 v164, 0
  v_mov_b32 v165, 0
  v_mov_b32 v166, 0
  v_mov_b32 v167, 0
  v_mov_b32 v168, 0
  v_mov_b32 v169, 0
  v_mov_b32 v170, 0
  v_mov_b32 v171, 0
  v_mov_b32 v172, 0
  v_mov_b32 v173, 0
  v_mov_b32 v174, 0
  v_mov_b32 v175, 0
  v_mov_b32 v176, 0
  v_mov_b32 v177, 0
  v_mov_b32 v178, 0
  v_mov_b32 v179, 0
  v_mov_b32 v180, 0
  v_mov_b32 v181, 0
  v_mov_b32 v182, 0
  v_mov_b32 v183, 0
  v_mov_b32 v184, 0
  v_mov_b32 v185, 0
  v_mov_b32 v186, 0
  v_mov_b32 v187, 0
  v_mov_b32 v188, 0
  v_mov_b32 v189, 0
  v_mov_b32 v190, 0
  v_mov_b32 v191, 0
  v_lshlrev_b32 v232, 8, v232
  v_lshl_add_u32 v242, v7, 4, v232
  s_waitcnt vmcnt(4)
  buffer_load_dwordx4 v5, s[40:43], s67 offen offset:1024 nt lds
  s_waitcnt vmcnt(4)
  buffer_load_dwordx4 v6, s[40:43], s67 offen offset:2048 nt lds
  s_waitcnt vmcnt(4)
  buffer_load_dwordx4 v6, s[40:43], s67 offen offset:3072 nt lds
  s_waitcnt vmcnt(4)
  s_add_u32 m0, s65, 8192
  s_add_u32 s67, s66, 32768
  buffer_load_dwordx4 v5, s[40:43], s67 offen offset:0 nt lds
  s_waitcnt vmcnt(4)
  buffer_load_dwordx4 v5, s[40:43], s67 offen offset:1024 nt lds
  s_waitcnt vmcnt(4)
  buffer_load_dwordx4 v6, s[40:43], s67 offen offset:2048 nt lds
  s_waitcnt vmcnt(4)
  buffer_load_dwordx4 v6, s[40:43], s67 offen offset:3072 nt lds
  s_waitcnt vmcnt(4)
  s_add_u32 m0, s65, 12288
  s_add_u32 s67, s66, 49152
  buffer_load_dwordx4 v5, s[40:43], s67 offen offset:0 nt lds
  s_waitcnt vmcnt(4)
  buffer_load_dwordx4 v5, s[40:43], s67 offen offset:1024 nt lds
  s_waitcnt vmcnt(4)
  buffer_load_dwordx4 v6, s[40:43], s67 offen offset:2048 nt lds
  s_waitcnt vmcnt(4)
  buffer_load_dwordx4 v6, s[40:43], s67 offen offset:3072 nt lds
  s_waitcnt vmcnt(4)
  s_add_u32 m0, s65, 16384
  s_add_u32 s67, s66, 65536
  buffer_load_dwordx4 v5, s[40:43], s67 offen offset:0 nt lds
  s_waitcnt vmcnt(4)
  buffer_load_dwordx4 v5, s[40:43], s67 offen offset:1024 nt lds
  s_waitcnt vmcnt(4)
  buffer_load_dwordx4 v6, s[40:43], s67 offen offset:2048 nt lds
  s_waitcnt vmcnt(4)
  buffer_load_dwordx4 v6, s[40:43], s67 offen offset:3072 nt lds
  s_waitcnt vmcnt(4)
  s_add_u32 m0, s65, 20480
  s_add_u32 s67, s66, 81920
  buffer_load_dwordx4 v5, s[40:43], s67 offen offset:0 nt lds
  s_waitcnt vmcnt(4)
  buffer_load_dwordx4 v5, s[40:43], s67 offen offset:1024 nt lds
  s_waitcnt vmcnt(4)
  buffer_load_dwordx4 v6, s[40:43], s67 offen offset:2048 nt lds
  s_waitcnt vmcnt(4)
  buffer_load_dwordx4 v6, s[40:43], s67 offen offset:3072 nt lds
  s_waitcnt vmcnt(4)
  s_add_u32 s67, s66, 98304
  buffer_load_dwordx4 v[32:35], v9, s[40:43], s67 offen offset:0 nt
  s_waitcnt vmcnt(4)
  buffer_load_dwordx4 v[36:39], v9, s[40:43], s67 offen offset:64 nt
  s_waitcnt vmcnt(4)
  buffer_load_dwordx4 v[40:43], v9, s[40:43], s67 offen offset:128 nt
  s_waitcnt vmcnt(4)
  buffer_load_dwordx4 v[44:47], v9, s[40:43], s67 offen offset:192 nt
  s_waitcnt vmcnt(4)
  s_add_u32 s67, s66, 114688
  buffer_load_dwordx4 v[48:51], v9, s[40:43], s67 offen offset:0 nt
  s_waitcnt vmcnt(4)
  buffer_load_dwordx4 v[52:55], v9, s[40:43], s67 offen offset:64 nt
  s_waitcnt vmcnt(4)
  buffer_load_dwordx4 v[56:59], v9, s[40:43], s67 offen offset:128 nt
  s_waitcnt vmcnt(4)
  buffer_load_dwordx4 v[60:63], v9, s[40:43], s67 offen offset:192 nt
  s_waitcnt vmcnt(4)
  s_add_u32 s67, s66, 131072
  buffer_load_dwordx4 v[64:67], v9, s[40:43], s67 offen offset:0 nt
  s_waitcnt vmcnt(4)
  buffer_load_dwordx4 v[68:71], v9, s[40:43], s67 offen offset:64 nt
  s_waitcnt vmcnt(4)
  buffer_load_dwordx4 v[72:75], v9, s[40:43], s67 offen offset:128 nt
  s_waitcnt vmcnt(4)
  buffer_load_dwordx4 v[76:79], v9, s[40:43], s67 offen offset:192 nt
  s_waitcnt vmcnt(4)
  s_add_u32 s67, s66, 147456
  buffer_load_dwordx4 v[80:83], v9, s[40:43], s67 offen offset:0 nt
  s_waitcnt vmcnt(4)
  buffer_load_dwordx4 v[84:87], v9, s[40:43], s67 offen offset:64 nt
  s_waitcnt vmcnt(4)
  buffer_load_dwordx4 v[88:91], v9, s[40:43], s67 offen offset:128 nt
  s_waitcnt vmcnt(4)
  buffer_load_dwordx4 v[92:95], v9, s[40:43], s67 offen offset:192 nt
  s_mov_b32 s94, 4000000
L_lw_37:
  ds_read_b32 v232, v2 offset:8
  s_waitcnt lgkmcnt(0)
  v_readfirstlane_b32 s95, v232
  s_cmp_ge_u32 s95, 1
  s_cbranch_scc1 L_lwd_38
  s_sleep 1
  s_sub_u32 s94, s94, 1
  s_cmp_lg_u32 s94, 0
  s_cbranch_scc1 L_lw_37
  s_branch L_end
L_lwd_38:
  s_mov_b32 exec_lo, 0x30003
  s_mov_b32 exec_hi, 0x30003
  ds_read_b128 v[128:131], v242 offset:512
  ds_read_b128 v[132:135], v242 offset:576
  ds_read_b128 v[136:139], v242 offset:640
  ds_read_b128 v[140:143], v242 offset:704
  s_waitcnt lgkmcnt(0)
  s_mov_b32 exec_lo, 0x300030
  s_mov_b32 exec_hi, 0x300030
  ds_read_b128 v[144:147], v242 offset:512
  ds_read_b128 v[148:151], v242 offset:576
  ds_read_b128 v[152:155], v242 offset:640
  ds_read_b128 v[156:159], v242 offset:704
  s_waitcnt lgkmcnt(0)
  s_mov_b32 exec_lo, 0x3000300
  s_mov_b32 exec_hi, 0x3000300
  ds_read_b128 v[160:163], v242 offset:512
  ds_read_b128 v[164:167], v242 offset:576
  ds_read_b128 v[168:171], v242 offset:640
  ds_read_b128 v[172:175], v242 offset:704
  s_waitcnt lgkmcnt(0)
  s_mov_b32 exec_lo, 0x30003000
  s_mov_b32 exec_hi, 0x30003000
  ds_read_b128 v[176:179], v242 offset:512
  ds_read_b128 v[180:183], v242 offset:576
  ds_read_b128 v[184:187], v242 offset:640
  ds_read_b128 v[188:191], v242 offset:704
  s_waitcnt lgkmcnt(0)
  s_mov_b64 exec, -1
  ds_read_b128 v[192:195], v10 offset:0
  ds_read_b128 v[196:199], v11 offset:0
  ds_read_b128 v[200:203], v12 offset:0
  ds_read_b128 v[204:207], v13 offset:0
  s_waitcnt lgkmcnt(3)
  v_mfma_f32_16x16x32_bf16 v[208:211], v[128:131], v[192:195], 0
  s_waitcnt lgkmcnt(2)
  v_mfma_f32_16x16x32_bf16 v[208:211], v[132:135], v[196:199], v[208:211]
  s_waitcnt lgkmcnt(1)
  v_mfma_f32_16x16x32_bf16 v[208:211], v[136:139], v[200:203], v[208:211]
  s_waitcnt lgkmcnt(0)
  v_mfma_f32_16x16x32_bf16 v[208:211], v[140:143], v[204:207], v[208:211]
  s_waitcnt vmcnt(4)
  s_add_u32 m0, s65, 0
  s_add_u32 s67, s66, 163840
  buffer_load_dwordx4 v5, s[40:43], s67 offen offset:0 nt lds
  ds_read_b128 v[192:195], v10 offset:4096
  ds_read_b128 v[196:199], v11 offset:4096
  ds_read_b128 v[200:203], v12 offset:4096
  ds_read_b128 v[204:207], v13 offset:4096
  s_waitcnt lgkmcnt(3)
  v_mfma_f32_16x16x32_bf16 v[208:211], v[144:147], v[192:195], v[208:211]
  s_waitcnt lgkmcnt(2)
  v_mfma_f32_16x16x32_bf16 v[208:211], v[148:151], v[196:199], v[208:211]
  s_waitcnt lgkmcnt(1)
  v_mfma_f32_16x16x32_bf16 v[208:211], v[152:155], v[200:203], v[208:211]
  s_waitcnt lgkmcnt(0)
  v_mfma_f32_16x16x32_bf16 v[208:211], v[156:159], v[204:207], v[208:211]
  s_waitcnt vmcnt(4)
  buffer_load_dwordx4 v5, s[40:43], s67 offen offset:1024 nt lds
  ds_read_b128 v[192:195], v10 offset:8192
  ds_read_b128 v[196:199], v11 offset:8192
  ds_read_b128 v[200:203], v12 offset:8192
  ds_read_b128 v[204:207], v13 offset:8192
  s_waitcnt lgkmcnt(3)
  v_mfma_f32_16x16x32_bf16 v[208:211], v[160:163], v[192:195], v[208:211]
  s_waitcnt lgkmcnt(2)
  v_mfma_f32_16x16x32_bf16 v[208:211], v[164:167], v[196:199], v[208:211]
  s_waitcnt lgkmcnt(1)
  v_mfma_f32_16x16x32_bf16 v[208:211], v[168:171], v[200:203], v[208:211]
  s_waitcnt lgkmcnt(0)
  v_mfma_f32_16x16x32_bf16 v[208:211], v[172:175], v[204:207], v[208:211]
  s_waitcnt vmcnt(4)
  buffer_load_dwordx4 v6, s[40:43], s67 offen offset:2048 nt lds
  ds_read_b128 v[192:195], v10 offset:12288
  ds_read_b128 v[196:199], v11 offset:12288
  ds_read_b128 v[200:203], v12 offset:12288
  ds_read_b128 v[204:207], v13 offset:12288
  s_waitcnt lgkmcnt(3)
  v_mfma_f32_16x16x32_bf16 v[208:211], v[176:179], v[192:195], v[208:211]
  s_waitcnt lgkmcnt(2)
  v_mfma_f32_16x16x32_bf16 v[208:211], v[180:183], v[196:199], v[208:211]
  s_waitcnt lgkmcnt(1)
  v_mfma_f32_16x16x32_bf16 v[208:211], v[184:187], v[200:203], v[208:211]
  s_waitcnt lgkmcnt(0)
  v_mfma_f32_16x16x32_bf16 v[208:211], v[188:191], v[204:207], v[208:211]
  s_waitcnt vmcnt(4)
  buffer_load_dwordx4 v6, s[40:43], s67 offen offset:3072 nt lds
  ds_read_b128 v[192:195], v10 offset:16384
  ds_read_b128 v[196:199], v11 offset:16384
  ds_read_b128 v[200:203], v12 offset:16384
  ds_read_b128 v[204:207], v13 offset:16384
  s_nop 4
  v_cvt_pk_bf16_f32 v232, v208, v209
  v_lshlrev_b32 v233, 16, v232
  v_and_b32 v234, 0xffff0000, v232
  v_mul_f32 v233, s69, v233
  v_mul_f32 v234, s69, v234
  v_cvt_pk_bf16_f32 v232, v233, v234
  v_lshlrev_b32 v216, 16, v232
  v_and_b32 v217, 0xffff0000, v232
  s_waitcnt lgkmcnt(3)
  v_mfma_f32_16x16x32_bf16 v[212:215], v[128:131], v[192:195], 0
  s_waitcnt lgkmcnt(2)
  v_mfma_f32_16x16x32_bf16 v[212:215], v[132:135], v[196:199], v[212:215]
  s_waitcnt lgkmcnt(1)
  v_mfma_f32_16x16x32_bf16 v[212:215], v[136:139], v[200:203], v[212:215]
  s_waitcnt lgkmcnt(0)
  v_mfma_f32_16x16x32_bf16 v[212:215], v[140:143], v[204:207], v[212:215]
  s_waitcnt vmcnt(4)
  s_add_u32 m0, s65, 4096
  s_add_u32 s67, s66, 180224
  buffer_load_dwordx4 v5, s[40:43], s67 offen offset:0 nt lds
  ds_read_b128 v[192:195], v10 offset:20480
  ds_read_b128 v[196:199], v11 offset:20480
  ds_read_b128 v[200:203], v12 offset:20480
  ds_read_b128 v[204:207], v13 offset:20480
  s_waitcnt lgkmcnt(3)
  v_mfma_f32_16x16x32_bf16 v[212:215], v[144:147], v[192:195], v[212:215]
  s_waitcnt lgkmcnt(2)
  v_mfma_f32_16x16x32_bf16 v[212:215], v[148:151], v[196:199], v[212:215]
  s_waitcnt lgkmcnt(1)
  v_mfma_f32_16x16x32_bf16 v[212:215], v[152:155], v[200:203], v[212:215]
  s_waitcnt lgkmcnt(0)
  v_mfma_f32_16x16x32_bf16 v[212:215], v[156:159], v[204:207], v[212:215]
  s_waitcnt vmcnt(4)
  buffer_load_dwordx4 v5, s[40:43], s67 offen offset:1024 nt lds
  v_mfma_f32_16x16x32_bf16 v[212:215], v[160:163], v[32:35], v[212:215]
  v_mfma_f32_16x16x32_bf16 v[212:215], v[164:167], v[36:39], v[212:215]
  v_mfma_f32_16x16x32_bf16 v[212:215], v[168:171], v[40:43], v[212:215]
  v_mfma_f32_16x16x32_bf16 v[212:215], v[172:175], v[44:47], v[212:215]
  s_waitcnt vmcnt(4)
  buffer_load_dwordx4 v6, s[40:43], s67 offen offset:2048 nt lds
  v_mfma_f32_16x16x32_bf16 v[212:215], v[176:179], v[48:51], v[212:215]
  v_mfma_f32_16x16x32_bf16 v[212:215], v[180:183], v[52:55], v[212:215]
  v_mfma_f32_16x16x32_bf16 v[212:215], v[184:187], v[56:59], v[212:215]
  v_mfma_f32_16x16x32_bf16 v[212:215], v[188:191], v[60:63], v[212:215]
  s_waitcnt vmcnt(4)
  buffer_load_dwordx4 v6, s[40:43], s67 offen offset:3072 nt lds
  s_nop 7
  v_cvt_pk_bf16_f32 v232, v212, v213
  v_lshlrev_b32 v233, 16, v232
  v_and_b32 v234, 0xffff0000, v232
  v_mul_f32 v233, s69, v233
  v_mul_f32 v234, s69, v234
  v_cvt_pk_bf16_f32 v232, v233, v234
  v_lshlrev_b32 v218, 16, v232
  v_and_b32 v219, 0xffff0000, v232
  v_mfma_f32_16x16x32_bf16 v[208:211], v[128:131], v[64:67], 0
  v_mfma_f32_16x16x32_bf16 v[208:211], v[132:135], v[68:71], v[208:211]
  v_mfma_f32_16x16x32_bf16 v[208:211], v[136:139], v[72:75], v[208:211]
  v_mfma_f32_16x16x32_bf16 v[208:211], v[140:143], v[76:79], v[208:211]
  s_waitcnt vmcnt(4)
  s_add_u32 m0, s65, 8192
  s_add_u32 s67, s66, 196608
  buffer_load_dwordx4 v5, s[40:43], s67 offen offset:0 nt lds
  v_mfma_f32_16x16x32_bf16 v[208:211], v[144:147], v[80:83], v[208:211]
  v_mfma_f32_16x16x32_bf16 v[208:211], v[148:151], v[84:87], v[208:211]
  v_mfma_f32_16x16x32_bf16 v[208:211], v[152:155], v[88:91], v[208:211]
  v_mfma_f32_16x16x32_bf16 v[208:211], v[156:159], v[92:95], v[208:211]
  s_waitcnt vmcnt(4)
  buffer_load_dwordx4 v5, s[40:43], s67 offen offset:1024 nt lds
  ds_read_b128 v[192:195], v10 offset:0
  ds_read_b128 v[196:199], v11 offset:0
  ds_read_b128 v[200:203], v12 offset:0
  ds_read_b128 v[204:207], v13 offset:0
  s_waitcnt lgkmcnt(3)
  v_mfma_f32_16x16x32_bf16 v[208:211], v[160:163], v[192:195], v[208:211]
  s_waitcnt lgkmcnt(2)
  v_mfma_f32_16x16x32_bf16 v[208:211], v[164:167], v[196:199], v[208:211]
  s_waitcnt lgkmcnt(1)
  v_mfma_f32_16x16x32_bf16 v[208:211], v[168:171], v[200:203], v[208:211]
  s_waitcnt lgkmcnt(0)
  v_mfma_f32_16x16x32_bf16 v[208:211], v[172:175], v[204:207], v[208:211]
  s_waitcnt vmcnt(4)
  buffer_load_dwordx4 v6, s[40:43], s67 offen offset:2048 nt lds
  s_waitcnt vmcnt(4)
  buffer_load_dwordx4 v6, s[40:43], s67 offen offset:3072 nt lds
  s_waitcnt vmcnt(4)
  s_add_u32 m0, s65, 12288
  s_add_u32 s67, s66, 212992
  buffer_load_dwordx4 v5, s[40:43], s67 offen offset:0 nt lds
  ds_read_b128 v[192:195], v10 offset:4096
  ds_read_b128 v[196:199], v11 offset:4096
  ds_read_b128 v[200:203], v12 offset:4096
  ds_read_b128 v[204:207], v13 offset:4096
  s_waitcnt lgkmcnt(3)
  v_mfma_f32_16x16x32_bf16 v[208:211], v[176:179], v[192:195], v[208:211]
  s_waitcnt lgkmcnt(2)
  v_mfma_f32_16x16x32_bf16 v[208:211], v[180:183], v[196:199], v[208:211]
  s_waitcnt lgkmcnt(1)
  v_mfma_f32_16x16x32_bf16 v[208:211], v[184:187], v[200:203], v[208:211]
  s_waitcnt lgkmcnt(0)
  v_mfma_f32_16x16x32_bf16 v[208:211], v[188:191], v[204:207], v[208:211]
  s_waitcnt vmcnt(4)
  buffer_load_dwordx4 v5, s[40:43], s67 offen offset:1024 nt lds
  s_waitcnt vmcnt(4)
  buffer_load_dwordx4 v6, s[40:43], s67 offen offset:2048 nt lds
  s_waitcnt vmcnt(4)
  buffer_load_dwordx4 v6, s[40:43], s67 offen offset:3072 nt lds
  s_waitcnt vmcnt(4)
  s_add_u32 m0, s65, 16384
  s_add_u32 s67, s66, 229376
  buffer_load_dwordx4 v5, s[40:43], s67 offen offset:0 nt lds
  ds_read_b128 v[192:195], v10 offset:8192
  ds_read_b128 v[196:199], v11 offset:8192
  ds_read_b128 v[200:203], v12 offset:8192
  ds_read_b128 v[204:207], v13 offset:8192
  s_nop 4
  v_cvt_pk_bf16_f32 v232, v208, v209
  v_lshlrev_b32 v233, 16, v232
  v_and_b32 v234, 0xffff0000, v232
  v_mul_f32 v233, s69, v233
  v_mul_f32 v234, s69, v234
  v_cvt_pk_bf16_f32 v232, v233, v234
  v_lshlrev_b32 v220, 16, v232
  v_and_b32 v221, 0xffff0000, v232
  s_waitcnt lgkmcnt(3)
  v_mfma_f32_16x16x32_bf16 v[212:215], v[128:131], v[192:195], 0
  s_waitcnt lgkmcnt(2)
  v_mfma_f32_16x16x32_bf16 v[212:215], v[132:135], v[196:199], v[212:215]
  s_waitcnt lgkmcnt(1)
  v_mfma_f32_16x16x32_bf16 v[212:215], v[136:139], v[200:203], v[212:215]
  s_waitcnt lgkmcnt(0)
  v_mfma_f32_16x16x32_bf16 v[212:215], v[140:143], v[204:207], v[212:215]
  s_waitcnt vmcnt(4)
  buffer_load_dwordx4 v5, s[40:43], s67 offen offset:1024 nt lds
  s_waitcnt vmcnt(4)
  buffer_load_dwordx4 v6, s[40:43], s67 offen offset:2048 nt lds
  s_waitcnt vmcnt(4)
  buffer_load_dwordx4 v6, s[40:43], s67 offen offset:3072 nt lds
  s_waitcnt vmcnt(4)
  s_add_u32 m0, s65, 20480
  s_add_u32 s67, s66, 245760
  buffer_load_dwordx4 v5, s[40:43], s67 offen offset:0 nt lds
  ds_read_b128 v[192:195], v10 offset:12288
  ds_read_b128 v[196:199], v11 offset:12288
  ds_read_b128 v[200:203], v12 offset:12288
  ds_read_b128 v[204:207], v13 offset:12288
  s_waitcnt lgkmcnt(3)
  v_mfma_f32_16x16x32_bf16 v[212:215], v[144:147], v[192:195], v[212:215]
  s_waitcnt lgkmcnt(2)
  v_mfma_f32_16x16x32_bf16 v[212:215], v[148:151], v[196:199], v[212:215]
  s_waitcnt lgkmcnt(1)
  v_mfma_f32_16x16x32_bf16 v[212:215], v[152:155], v[200:203], v[212:215]
  s_waitcnt lgkmcnt(0)
  v_mfma_f32_16x16x32_bf16 v[212:215], v[156:159], v[204:207], v[212:215]
  s_waitcnt vmcnt(4)
  buffer_load_dwordx4 v5, s[40:43], s67 offen offset:1024 nt lds
  s_waitcnt vmcnt(4)
  buffer_load_dwordx4 v6, s[40:43], s67 offen offset:2048 nt lds
  s_waitcnt vmcnt(4)
  buffer_load_dwordx4 v6, s[40:43], s67 offen offset:3072 nt lds
  s_waitcnt vmcnt(4)
  s_add_u32 m0, s65, 0
  s_add_u32 s67, s66, 262144
  buffer_load_dwordx4 v5, s[40:43], s67 offen offset:0 nt lds
  ds_read_b128 v[192:195], v10 offset:16384
  ds_read_b128 v[196:199], v11 offset:16384
  ds_read_b128 v[200:203], v12 offset:16384
  ds_read_b128 v[204:207], v13 offset:16384
  s_waitcnt lgkmcnt(3)
  v_mfma_f32_16x16x32_bf16 v[212:215], v[160:163], v[192:195], v[212:215]
  s_waitcnt lgkmcnt(2)
  v_mfma_f32_16x16x32_bf16 v[212:215], v[164:167], v[196:199], v[212:215]
  s_waitcnt lgkmcnt(1)
  v_mfma_f32_16x16x32_bf16 v[212:215], v[168:171], v[200:203], v[212:215]
  s_waitcnt lgkmcnt(0)
  v_mfma_f32_16x16x32_bf16 v[212:215], v[172:175], v[204:207], v[212:215]
  s_waitcnt vmcnt(4)
  buffer_load_dwordx4 v5, s[40:43], s67 offen offset:1024 nt lds
  s_waitcnt vmcnt(4)
  buffer_load_dwordx4 v6, s[40:43], s67 offen offset:2048 nt lds
  s_waitcnt vmcnt(4)
  buffer_load_dwordx4 v6, s[40:43], s67 offen offset:3072 nt lds
  s_waitcnt vmcnt(4)
  s_add_u32 m0, s65, 4096
  s_add_u32 s67, s66, 278528
  buffer_load_dwordx4 v5, s[40:43], s67 offen offset:0 nt lds
  ds_read_b128 v[192:195], v10 offset:20480
  ds_read_b128 v[196:199], v11 offset:20480
  ds_read_b128 v[200:203], v12 offset:20480
  ds_read_b128 v[204:207], v13 offset:20480
  s_waitcnt lgkmcnt(3)
  v_mfma_f32_16x16x32_bf16 v[212:215], v[176:179], v[192:195], v[212:215]
  s_waitcnt lgkmcnt(2)
  v_mfma_f32_16x16x32_bf16 v[212:215], v[180:183], v[196:199], v[212:215]
  s_waitcnt lgkmcnt(1)
  v_mfma_f32_16x16x32_bf16 v[212:215], v[184:187], v[200:203], v[212:215]
  s_waitcnt lgkmcnt(0)
  v_mfma_f32_16x16x32_bf16 v[212:215], v[188:191], v[204:207], v[212:215]
  s_waitcnt vmcnt(4)
  buffer_load_dwordx4 v5, s[40:43], s67 offen offset:1024 nt lds
  s_waitcnt vmcnt(4)
  buffer_load_dwordx4 v6, s[40:43], s67 offen offset:2048 nt lds
  s_waitcnt vmcnt(4)
  buffer_load_dwordx4 v6, s[40:43], s67 offen offset:3072 nt lds
  s_waitcnt vmcnt(4)
  s_add_u32 m0, s65, 8192
  s_add_u32 s67, s66, 294912
  buffer_load_dwordx4 v5, s[40:43], s67 offen offset:0 nt lds
  ds_read_b128 v[192:195], v10 offset:0
  ds_read_b128 v[196:199], v11 offset:0
  ds_read_b128 v[200:203], v12 offset:0
  ds_read_b128 v[204:207], v13 offset:0
  s_nop 4
  v_cvt_pk_bf16_f32 v232, v212, v213
  v_lshlrev_b32 v233, 16, v232
  v_and_b32 v234, 0xffff0000, v232
  v_mul_f32 v233, s69, v233
  v_mul_f32 v234, s69, v234
  v_cvt_pk_bf16_f32 v232, v233, v234
  v_lshlrev_b32 v222, 16, v232
  v_and_b32 v223, 0xffff0000, v232
  s_waitcnt lgkmcnt(3)
  v_mfma_f32_16x16x32_bf16 v[208:211], v[128:131], v[192:195], 0
  s_waitcnt lgkmcnt(2)
  v_mfma_f32_16x16x32_bf16 v[208:211], v[132:135], v[196:199], v[208:211]
  s_waitcnt lgkmcnt(1)
  v_mfma_f32_16x16x32_bf16 v[208:211], v[136:139], v[200:203], v[208:211]
  s_waitcnt lgkmcnt(0)
  v_mfma_f32_16x16x32_bf16 v[208:211], v[140:143], v[204:207], v[208:211]
  s_waitcnt vmcnt(4)
  buffer_load_dwordx4 v5, s[40:43], s67 offen offset:1024 nt lds
  s_waitcnt vmcnt(4)
  buffer_load_dwordx4 v6, s[40:43], s67 offen offset:2048 nt lds
  s_waitcnt vmcnt(4)
  buffer_load_dwordx4 v6, s[40:43], s67 offen offset:3072 nt lds
  s_waitcnt vmcnt(4)
  s_add_u32 m0, s65, 12288
  s_add_u32 s67, s66, 311296
  buffer_load_dwordx4 v5, s[40:43], s67 offen offset:0 nt lds
  ds_read_b128 v[192:195], v10 offset:4096
  ds_read_b128 v[196:199], v11 offset:4096
  ds_read_b128 v[200:203], v12 offset:4096
  ds_read_b128 v[204:207], v13 offset:4096
  s_waitcnt lgkmcnt(3)
  v_mfma_f32_16x16x32_bf16 v[208:211], v[144:147], v[192:195], v[208:211]
  s_waitcnt lgkmcnt(2)
  v_mfma_f32_16x16x32_bf16 v[208:211], v[148:151], v[196:199], v[208:211]
  s_waitcnt lgkmcnt(1)
  v_mfma_f32_16x16x32_bf16 v[208:211], v[152:155], v[200:203], v[208:211]
  s_waitcnt lgkmcnt(0)
  v_mfma_f32_16x16x32_bf16 v[208:211], v[156:159], v[204:207], v[208:211]
  s_waitcnt vmcnt(4)
  buffer_load_dwordx4 v5, s[40:43], s67 offen offset:1024 nt lds
  s_waitcnt vmcnt(4)
  buffer_load_dwordx4 v6, s[40:43], s67 offen offset:2048 nt lds
  s_waitcnt vmcnt(4)
  buffer_load_dwordx4 v6, s[40:43], s67 offen offset:3072 nt lds
  s_waitcnt vmcnt(4)
  s_add_u32 m0, s65, 16384
  s_add_u32 s67, s66, 327680
  buffer_load_dwordx4 v5, s[40:43], s67 offen offset:0 nt lds
  ds_read_b128 v[192:195], v10 offset:8192
  ds_read_b128 v[196:199], v11 offset:8192
  ds_read_b128 v[200:203], v12 offset:8192
  ds_read_b128 v[204:207], v13 offset:8192
  s_waitcnt lgkmcnt(3)
  v_mfma_f32_16x16x32_bf16 v[208:211], v[160:163], v[192:195], v[208:211]
  s_waitcnt lgkmcnt(2)
  v_mfma_f32_16x16x32_bf16 v[208:211], v[164:167], v[196:199], v[208:211]
  s_waitcnt lgkmcnt(1)
  v_mfma_f32_16x16x32_bf16 v[208:211], v[168:171], v[200:203], v[208:211]
  s_waitcnt lgkmcnt(0)
  v_mfma_f32_16x16x32_bf16 v[208:211], v[172:175], v[204:207], v[208:211]
  s_waitcnt vmcnt(4)
  buffer_load_dwordx4 v5, s[40:43], s67 offen offset:1024 nt lds
  s_waitcnt vmcnt(4)
  buffer_load_dwordx4 v6, s[40:43], s67 offen offset:2048 nt lds
  s_waitcnt vmcnt(4)
  buffer_load_dwordx4 v6, s[40:43], s67 offen offset:3072 nt lds
  s_waitcnt vmcnt(4)
  s_add_u32 m0, s65, 20480
  s_add_u32 s67, s66, 344064
  buffer_load_dwordx4 v5, s[40:43], s67 offen offset:0 nt lds
  ds_read_b128 v[192:195], v10 offset:12288
  ds_read_b128 v[196:199], v11 offset:12288
  ds_read_b128 v[200:203], v12 offset:12288
  ds_read_b128 v[204:207], v13 offset:12288
  s_waitcnt lgkmcnt(3)
  v_mfma_f32_16x16x32_bf16 v[208:211], v[176:179], v[192:195], v[208:211]
  s_waitcnt lgkmcnt(2)
  v_mfma_f32_16x16x32_bf16 v[208:211], v[180:183], v[196:199], v[208:211]
  s_waitcnt lgkmcnt(1)
  v_mfma_f32_16x16x32_bf16 v[208:211], v[184:187], v[200:203], v[208:211]
  s_waitcnt lgkmcnt(0)
  v_mfma_f32_16x16x32_bf16 v[208:211], v[188:191], v[204:207], v[208:211]
  s_waitcnt vmcnt(4)
  buffer_load_dwordx4 v5, s[40:43], s67 offen offset:1024 nt lds
  s_waitcnt vmcnt(4)
  buffer_load_dwordx4 v6, s[40:43], s67 offen offset:2048 nt lds
  s_waitcnt vmcnt(4)
  buffer_load_dwordx4 v6, s[40:43], s67 offen offset:3072 nt lds
  s_waitcnt vmcnt(4)
  s_add_u32 m0, s65, 0
  s_add_u32 s67, s66, 360448
  buffer_load_dwordx4 v5, s[40:43], s67 offen offset:0 nt lds
  ds_read_b128 v[192:195], v10 offset:16384
  ds_read_b128 v[196:199], v11 offset:16384
  ds_read_b128 v[200:203], v12 offset:16384
  ds_read_b128 v[204:207], v13 offset:16384
  s_nop 4
  v_cvt_pk_bf16_f32 v232, v208, v209
  v_lshlrev_b32 v233, 16, v232
  v_and_b32 v234, 0xffff0000, v232
  v_mul_f32 v233, s69, v233
  v_mul_f32 v234, s69, v234
  v_cvt_pk_bf16_f32 v232, v233, v234
  v_lshlrev_b32 v224, 16, v232
  v_and_b32 v225, 0xffff0000, v232
  s_waitcnt lgkmcnt(3)
  v_mfma_f32_16x16x32_bf16 v[212:215], v[128:131], v[192:195], 0
  s_waitcnt lgkmcnt(2)
  v_mfma_f32_16x16x32_bf16 v[212:215], v[132:135], v[196:199], v[212:215]
  s_waitcnt lgkmcnt(1)
  v_mfma_f32_16x16x32_bf16 v[212:215], v[136:139], v[200:203], v[212:215]
  s_waitcnt lgkmcnt(0)
  v_mfma_f32_16x16x32_bf16 v[212:215], v[140:143], v[204:207], v[212:215]
  s_waitcnt vmcnt(4)
  buffer_load_dwordx4 v5, s[40:43], s67 offen offset:1024 nt lds
  s_waitcnt vmcnt(4)
  buffer_load_dwordx4 v6, s[40:43], s67 offen offset:2048 nt lds
  s_waitcnt vmcnt(4)
  buffer_load_dwordx4 v6, s[40:43], s67 offen offset:3072 nt lds
  s_waitcnt vmcnt(4)
  s_add_u32 m0, s65, 4096
  s_add_u32 s67, s66, 376832
  buffer_load_dwordx4 v5, s[40:43], s67 offen offset:0 nt lds
  ds_read_b128 v[192:195], v10 offset:20480
  ds_read_b128 v[196:199], v11 offset:20480
  ds_read_b128 v[200:203], v12 offset:20480
  ds_read_b128 v[204:207], v13 offset:20480
  s_waitcnt lgkmcnt(3)
  v_mfma_f32_16x16x32_bf16 v[212:215], v[144:147], v[192:195], v[212:215]
  s_waitcnt lgkmcnt(2)
  v_mfma_f32_16x16x32_bf16 v[212:215], v[148:151], v[196:199], v[212:215]
  s_waitcnt lgkmcnt(1)
  v_mfma_f32_16x16x32_bf16 v[212:215], v[152:155], v[200:203], v[212:215]
  s_waitcnt lgkmcnt(0)
  v_mfma_f32_16x16x32_bf16 v[212:215], v[156:159], v[204:207], v[212:215]
  s_waitcnt vmcnt(4)
  buffer_load_dwordx4 v5, s[40:43], s67 offen offset:1024 nt lds
  s_waitcnt vmcnt(4)
  buffer_load_dwordx4 v6, s[40:43], s67 offen offset:2048 nt lds
  s_waitcnt vmcnt(4)
  buffer_load_dwordx4 v6, s[40:43], s67 offen offset:3072 nt lds
  s_waitcnt vmcnt(4)
  s_add_u32 m0, s65, 8192
  s_add_u32 s67, s66, 393216
  buffer_load_dwordx4 v5, s[40:43], s67 offen offset:0 nt lds
  ds_read_b128 v[192:195], v10 offset:0
  ds_read_b128 v[196:199], v11 offset:0
  ds_read_b128 v[200:203], v12 offset:0
  ds_read_b128 v[204:207], v13 offset:0
  s_waitcnt lgkmcnt(3)
  v_mfma_f32_16x16x32_bf16 v[212:215], v[160:163], v[192:195], v[212:215]
  s_waitcnt lgkmcnt(2)
  v_mfma_f32_16x16x32_bf16 v[212:215], v[164:167], v[196:199], v[212:215]
  s_waitcnt lgkmcnt(1)
  v_mfma_f32_16x16x32_bf16 v[212:215], v[168:171], v[200:203], v[212:215]
  s_waitcnt lgkmcnt(0)
  v_mfma_f32_16x16x32_bf16 v[212:215], v[172:175], v[204:207], v[212:215]
  s_waitcnt vmcnt(4)
  buffer_load_dwordx4 v5, s[40:43], s67 offen offset:1024 nt lds
  s_waitcnt vmcnt(4)
  buffer_load_dwordx4 v6, s[40:43], s67 offen offset:2048 nt lds
  s_waitcnt vmcnt(4)
  buffer_load_dwordx4 v6, s[40:43], s67 offen offset:3072 nt lds
  s_waitcnt vmcnt(4)
  s_add_u32 m0, s65, 12288
  s_add_u32 s67, s66, 409600
  buffer_load_dwordx4 v5, s[40:43], s67 offen offset:0 nt lds
  ds_read_b128 v[192:195], v10 offset:4096
  ds_read_b128 v[196:199], v11 offset:4096
  ds_read_b128 v[200:203], v12 offset:4096
  ds_read_b128 v[204:207], v13 offset:4096
  s_waitcnt lgkmcnt(3)
  v_mfma_f32_16x16x32_bf16 v[212:215], v[176:179], v[192:195], v[212:215]
  s_waitcnt lgkmcnt(2)
  v_mfma_f32_16x16x32_bf16 v[212:215], v[180:183], v[196:199], v[212:215]
  s_waitcnt lgkmcnt(1)
  v_mfma_f32_16x16x32_bf16 v[212:215], v[184:187], v[200:203], v[212:215]
  s_waitcnt lgkmcnt(0)
  v_mfma_f32_16x16x32_bf16 v[212:215], v[188:191], v[204:207], v[212:215]
  s_waitcnt vmcnt(4)
  buffer_load_dwordx4 v5, s[40:43], s67 offen offset:1024 nt lds
  s_waitcnt vmcnt(4)
  buffer_load_dwordx4 v6, s[40:43], s67 offen offset:2048 nt lds
  s_waitcnt vmcnt(4)
  buffer_load_dwordx4 v6, s[40:43], s67 offen offset:3072 nt lds
  s_waitcnt vmcnt(4)
  s_add_u32 m0, s65, 16384
  s_add_u32 s67, s66, 425984
  buffer_load_dwordx4 v5, s[40:43], s67 offen offset:0 nt lds
  ds_read_b128 v[192:195], v10 offset:8192
  ds_read_b128 v[196:199], v11 offset:8192
  ds_read_b128 v[200:203], v12 offset:8192
  ds_read_b128 v[204:207], v13 offset:8192
  s_nop 4
  v_cvt_pk_bf16_f32 v232, v212, v213
  v_lshlrev_b32 v233, 16, v232
  v_and_b32 v234, 0xffff0000, v232
  v_mul_f32 v233, s69, v233
  v_mul_f32 v234, s69, v234
  v_cvt_pk_bf16_f32 v232, v233, v234
  v_lshlrev_b32 v226, 16, v232
  v_and_b32 v227, 0xffff0000, v232
  s_waitcnt lgkmcnt(3)
  v_mfma_f32_16x16x32_bf16 v[208:211], v[128:131], v[192:195], 0
  s_waitcnt lgkmcnt(2)
  v_mfma_f32_16x16x32_bf16 v[208:211], v[132:135], v[196:199], v[208:211]
  s_waitcnt lgkmcnt(1)
  v_mfma_f32_16x16x32_bf16 v[208:211], v[136:139], v[200:203], v[208:211]
  s_waitcnt lgkmcnt(0)
  v_mfma_f32_16x16x32_bf16 v[208:211], v[140:143], v[204:207], v[208:211]
  s_waitcnt vmcnt(4)
  buffer_load_dwordx4 v5, s[40:43], s67 offen offset:1024 nt lds
  s_waitcnt vmcnt(4)
  buffer_load_dwordx4 v6, s[40:43], s67 offen offset:2048 nt lds
  s_waitcnt vmcnt(4)
  buffer_load_dwordx4 v6, s[40:43], s67 offen offset:3072 nt lds
  s_waitcnt vmcnt(4)
  s_add_u32 m0, s65, 20480
  s_add_u32 s67, s66, 442368
  buffer_load_dwordx4 v5, s[40:43], s67 offen offset:0 nt lds
  ds_read_b128 v[192:195], v10 offset:12288
  ds_read_b128 v[196:199], v11 offset:12288
  ds_read_b128 v[200:203], v12 offset:12288
  ds_read_b128 v[204:207], v13 offset:12288
  s_waitcnt lgkmcnt(3)
  v_mfma_f32_16x16x32_bf16 v[208:211], v[144:147], v[192:195], v[208:211]
  s_waitcnt lgkmcnt(2)
  v_mfma_f32_16x16x32_bf16 v[208:211], v[148:151], v[196:199], v[208:211]
  s_waitcnt lgkmcnt(1)
  v_mfma_f32_16x16x32_bf16 v[208:211], v[152:155], v[200:203], v[208:211]
  s_waitcnt lgkmcnt(0)
  v_mfma_f32_16x16x32_bf16 v[208:211], v[156:159], v[204:207], v[208:211]
  s_waitcnt vmcnt(4)
  buffer_load_dwordx4 v5, s[40:43], s67 offen offset:1024 nt lds
  s_waitcnt vmcnt(4)
  buffer_load_dwordx4 v6, s[40:43], s67 offen offset:2048 nt lds
  s_waitcnt vmcnt(4)
  buffer_load_dwordx4 v6, s[40:43], s67 offen offset:3072 nt lds
  s_waitcnt vmcnt(4)
  s_add_u32 m0, s65, 0
  s_add_u32 s67, s66, 458752
  buffer_load_dwordx4 v5, s[40:43], s67 offen offset:0 nt lds
  ds_read_b128 v[192:195], v10 offset:16384
  ds_read_b128 v[196:199], v11 offset:16384
  ds_read_b128 v[200:203], v12 offset:16384
  ds_read_b128 v[204:207], v13 offset:16384
  s_waitcnt lgkmcnt(3)
  v_mfma_f32_16x16x32_bf16 v[208:211], v[160:163], v[192:195], v[208:211]
  s_waitcnt lgkmcnt(2)
  v_mfma_f32_16x16x32_bf16 v[208:211], v[164:167], v[196:199], v[208:211]
  s_waitcnt lgkmcnt(1)
  v_mfma_f32_16x16x32_bf16 v[208:211], v[168:171], v[200:203], v[208:211]
  s_waitcnt lgkmcnt(0)
  v_mfma_f32_16x16x32_bf16 v[208:211], v[172:175], v[204:207], v[208:211]
  s_waitcnt vmcnt(4)
  buffer_load_dwordx4 v5, s[40:43], s67 offen offset:1024 nt lds
  s_waitcnt vmcnt(4)
  buffer_load_dwordx4 v6, s[40:43], s67 offen offset:2048 nt lds
  s_waitcnt vmcnt(4)
  buffer_load_dwordx4 v6, s[40:43], s67 offen offset:3072 nt lds
  s_waitcnt vmcnt(4)
  s_add_u32 m0, s65, 4096
  s_add_u32 s67, s66, 475136
  buffer_load_dwordx4 v5, s[40:43], s67 offen offset:0 nt lds
  ds_read_b128 v[192:195], v10 offset:20480
  ds_read_b128 v[196:199], v11 offset:20480
  ds_read_b128 v[200:203], v12 offset:20480
  ds_read_b128 v[204:207], v13 offset:20480
  s_waitcnt lgkmcnt(3)
  v_mfma_f32_16x16x32_bf16 v[208:211], v[176:179], v[192:195], v[208:211]
  s_waitcnt lgkmcnt(2)
  v_mfma_f32_16x16x32_bf16 v[208:211], v[180:183], v[196:199], v[208:211]
  s_waitcnt lgkmcnt(1)
  v_mfma_f32_16x16x32_bf16 v[208:211], v[184:187], v[200:203], v[208:211]
  s_waitcnt lgkmcnt(0)
  v_mfma_f32_16x16x32_bf16 v[208:211], v[188:191], v[204:207], v[208:211]
  s_waitcnt vmcnt(4)
  buffer_load_dwordx4 v5, s[40:43], s67 offen offset:1024 nt lds
  s_waitcnt vmcnt(4)
  buffer_load_dwordx4 v6, s[40:43], s67 offen offset:2048 nt lds
  s_waitcnt vmcnt(4)
  buffer_load_dwordx4 v6, s[40:43], s67 offen offset:3072 nt lds
  s_waitcnt vmcnt(4)
  s_add_u32 m0, s65, 8192
  s_add_u32 s67, s66, 491520
  buffer_load_dwordx4 v5, s[40:43], s67 offen offset:0 nt lds
  ds_read_b128 v[192:195], v10 offset:0
  ds_read_b128 v[196:199], v11 offset:0
  ds_read_b128 v[200:203], v12 offset:0
  ds_read_b128 v[204:207], v13 offset:0
  s_nop 4
  v_cvt_pk_bf16_f32 v232, v208, v209
  v_lshlrev_b32 v233, 16, v232
  v_and_b32 v234, 0xffff0000, v232
  v_mul_f32 v233, s69, v233
  v_mul_f32 v234, s69, v234
  v_cvt_pk_bf16_f32 v232, v233, v234
  v_lshlrev_b32 v228, 16, v232
  v_and_b32 v229, 0xffff0000, v232
  s_waitcnt lgkmcnt(3)
  v_mfma_f32_16x16x32_bf16 v[212:215], v[128:131], v[192:195], 0
  s_waitcnt lgkmcnt(2)
  v_mfma_f32_16x16x32_bf16 v[212:215], v[132:135], v[196:199], v[212:215]
  s_waitcnt lgkmcnt(1)
  v_mfma_f32_16x16x32_bf16 v[212:215], v[136:139], v[200:203], v[212:215]
  s_waitcnt lgkmcnt(0)
  v_mfma_f32_16x16x32_bf16 v[212:215], v[140:143], v[204:207], v[212:215]
  s_waitcnt vmcnt(4)
  buffer_load_dwordx4 v5, s[40:43], s67 offen offset:1024 nt lds
  s_waitcnt vmcnt(4)
  buffer_load_dwordx4 v6, s[40:43], s67 offen offset:2048 nt lds
  s_waitcnt vmcnt(4)
  buffer_load_dwordx4 v6, s[40:43], s67 offen offset:3072 nt lds
  s_waitcnt vmcnt(4)
  s_add_u32 m0, s65, 12288
  s_add_u32 s67, s66, 507904
  buffer_load_dwordx4 v5, s[40:43], s67 offen offset:0 nt lds
  ds_read_b128 v[192:195], v10 offset:4096
  ds_read_b128 v[196:199], v11 offset:4096
  ds_read_b128 v[200:203], v12 offset:4096
  ds_read_b128 v[204:207], v13 offset:4096
  s_waitcnt lgkmcnt(3)
  v_mfma_f32_16x16x32_bf16 v[212:215], v[144:147], v[192:195], v[212:215]
  s_waitcnt lgkmcnt(2)
  v_mfma_f32_16x16x32_bf16 v[212:215], v[148:151], v[196:199], v[212:215]
  s_waitcnt lgkmcnt(1)
  v_mfma_f32_16x16x32_bf16 v[212:215], v[152:155], v[200:203], v[212:215]
  s_waitcnt lgkmcnt(0)
  v_mfma_f32_16x16x32_bf16 v[212:215], v[156:159], v[204:207], v[212:215]
  s_waitcnt vmcnt(4)
  buffer_load_dwordx4 v5, s[40:43], s67 offen offset:1024 nt lds
  s_waitcnt vmcnt(4)
  buffer_load_dwordx4 v6, s[40:43], s67 offen offset:2048 nt lds
  s_waitcnt vmcnt(4)
  buffer_load_dwordx4 v6, s[40:43], s67 offen offset:3072 nt lds
  s_waitcnt vmcnt(4)
  s_add_u32 m0, s65, 16384
  s_add_u32 s67, s66, 0
  buffer_load_dwordx4 v5, s[44:47], s67 offen offset:0 nt lds
  ds_read_b128 v[192:195], v10 offset:8192
  ds_read_b128 v[196:199], v11 offset:8192
  ds_read_b128 v[200:203], v12 offset:8192
  ds_read_b128 v[204:207], v13 offset:8192
  s_waitcnt lgkmcnt(3)
  v_mfma_f32_16x16x32_bf16 v[212:215], v[160:163], v[192:195], v[212:215]
  s_waitcnt lgkmcnt(2)
  v_mfma_f32_16x16x32_bf16 v[212:215], v[164:167], v[196:199], v[212:215]
  s_waitcnt lgkmcnt(1)
  v_mfma_f32_16x16x32_bf16 v[212:215], v[168:171], v[200:203], v[212:215]
  s_waitcnt lgkmcnt(0)
  v_mfma_f32_16x16x32_bf16 v[212:215], v[172:175], v[204:207], v[212:215]
  s_waitcnt vmcnt(4)
  buffer_load_dwordx4 v5, s[44:47], s67 offen offset:1024 nt lds
  s_waitcnt vmcnt(4)
  buffer_load_dwordx4 v6, s[44:47], s67 offen offset:2048 nt lds
  s_waitcnt vmcnt(4)
  buffer_load_dwordx4 v6, s[44:47], s67 offen offset:3072 nt lds
  s_waitcnt vmcnt(4)
  s_add_u32 m0, s65, 20480
  s_add_u32 s67, s66, 16384
  buffer_load_dwordx4 v5, s[44:47], s67 offen offset:0 nt lds
  ds_read_b128 v[192:195], v10 offset:12288
  ds_read_b128 v[196:199], v11 offset:12288
  ds_read_b128 v[200:203], v12 offset:12288
  ds_read_b128 v[204:207], v13 offset:12288
  s_waitcnt lgkmcnt(3)
  v_mfma_f32_16x16x32_bf16 v[212:215], v[176:179], v[192:195], v[212:215]
  s_waitcnt lgkmcnt(2)
  v_mfma_f32_16x16x32_bf16 v[212:215], v[180:183], v[196:199], v[212:215]
  s_waitcnt lgkmcnt(1)
  v_mfma_f32_16x16x32_bf16 v[212:215], v[184:187], v[200:203], v[212:215]
  s_waitcnt lgkmcnt(0)
  v_mfma_f32_16x16x32_bf16 v[212:215], v[188:191], v[204:207], v[212:215]
  s_waitcnt vmcnt(4)
  buffer_load_dwordx4 v5, s[44:47], s67 offen offset:1024 nt lds
  s_nop 7
  s_nop 3
  v_cvt_pk_bf16_f32 v232, v212, v213
  v_lshlrev_b32 v233, 16, v232
  v_and_b32 v234, 0xffff0000, v232
  v_mul_f32 v233, s69, v233
  v_mul_f32 v234, s69, v234
  v_cvt_pk_bf16_f32 v232, v233, v234
  v_lshlrev_b32 v230, 16, v232
  v_and_b32 v231, 0xffff0000, v232
  v_max3_f32 v236, v216, v218, v220
  v_max3_f32 v236, v236, v222, v224
  v_max3_f32 v236, v236, v226, v228
  v_max_f32 v236, v236, v230
  s_nop 1
  v_max_f32_dpp v236, v236, v236 quad_perm:[1,0,3,2] row_mask:0xf bank_mask:0xf
  s_nop 1
  v_max_f32_dpp v236, v236, v236 quad_perm:[2,3,0,1] row_mask:0xf bank_mask:0xf
  s_nop 1
  v_max_f32_dpp v236, v236, v236 row_half_mirror row_mask:0xf bank_mask:0xf
  s_nop 1
  v_max_f32_dpp v236, v236, v236 row_mirror row_mask:0xf bank_mask:0xf
  v_mov_b32 v240, v236
  s_nop 1
  v_permlane16_swap_b32 v236, v240
  s_nop 1
  v_max_f32 v236, v236, v240
  v_mov_b32 v240, v236
  s_nop 1
  v_permlane32_swap_b32 v236, v240
  s_nop 1
  v_max_f32 v236, v236, v240
  v_max3_f32 v237, v217, v219, v221
  v_max3_f32 v237, v237, v223, v225
  v_max3_f32 v237, v237, v227, v229
  v_max_f32 v237, v237, v231
  s_nop 1
  v_max_f32_dpp v237, v237, v237 quad_perm:[1,0,3,2] row_mask:0xf bank_mask:0xf
  s_nop 1
  v_max_f32_dpp v237, v237, v237 quad_perm:[2,3,0,1] row_mask:0xf bank_mask:0xf
  s_nop 1
  v_max_f32_dpp v237, v237, v237 row_half_mirror row_mask:0xf bank_mask:0xf
  s_nop 1
  v_max_f32_dpp v237, v237, v237 row_mirror row_mask:0xf bank_mask:0xf
  v_mov_b32 v240, v237
  s_nop 1
  v_permlane16_swap_b32 v237, v240
  s_nop 1
  v_max_f32 v237, v237, v240
  v_mov_b32 v240, v237
  s_nop 1
  v_permlane32_swap_b32 v237, v240
  s_nop 1
  v_max_f32 v237, v237, v240
  v_sub_f32 v240, v216, v236
  v_mul_f32 v240, s70, v240
  v_exp_f32 v240, v240
  s_nop 0
  v_mov_b32 v238, v240
  v_sub_f32 v240, v218, v236
  v_mul_f32 v240, s70, v240
  v_exp_f32 v240, v240
  s_nop 0
  v_add_f32 v238, v238, v240
  v_sub_f32 v240, v220, v236
  v_mul_f32 v240, s70, v240
  v_exp_f32 v240, v240
  s_nop 0
  v_add_f32 v238, v238, v240
  v_sub_f32 v240, v222, v236
  v_mul_f32 v240, s70, v240
  v_exp_f32 v240, v240
  s_nop 0
  v_add_f32 v238, v238, v240
  v_sub_f32 v240, v224, v236
  v_mul_f32 v240, s70, v240
  v_exp_f32 v240, v240
  s_nop 0
  v_add_f32 v238, v238, v240
  v_sub_f32 v240, v226, v236
  v_mul_f32 v240, s70, v240
  v_exp_f32 v240, v240
  s_nop 0
  v_add_f32 v238, v238, v240
  v_sub_f32 v240, v228, v236
  v_mul_f32 v240, s70, v240
  v_exp_f32 v240, v240
  s_nop 0
  v_add_f32 v238, v238, v240
  v_sub_f32 v240, v230, v236
  v_mul_f32 v240, s70, v240
  v_exp_f32 v240, v240
  s_nop 0
  v_add_f32 v238, v238, v240
  s_nop 1
  v_add_f32_dpp v238, v238, v238 quad_perm:[1,0,3,2] row_mask:0xf bank_mask:0xf
  s_nop 1
  v_add_f32_dpp v238, v238, v238 quad_perm:[2,3,0,1] row_mask:0xf bank_mask:0xf
  s_nop 1
  v_add_f32_dpp v238, v238, v238 row_half_mirror row_mask:0xf bank_mask:0xf
  s_nop 1
  v_add_f32_dpp v238, v238, v238 row_mirror row_mask:0xf bank_mask:0xf
  v_mov_b32 v240, v238
  s_nop 1
  v_permlane16_swap_b32 v238, v240
  s_nop 1
  v_add_f32 v238, v238, v240
  v_mov_b32 v240, v238
  s_nop 1
  v_permlane32_swap_b32 v238, v240
  s_nop 1
  v_add_f32 v238, v238, v240
  v_sub_f32 v240, v217, v237
  v_mul_f32 v240, s70, v240
  v_exp_f32 v240, v240
  s_nop 0
  v_mov_b32 v239, v240
  v_sub_f32 v240, v219, v237
  v_mul_f32 v240, s70, v240
  v_exp_f32 v240, v240
  s_nop 0
  v_add_f32 v239, v239, v240
  v_sub_f32 v240, v221, v237
  v_mul_f32 v240, s70, v240
  v_exp_f32 v240, v240
  s_nop 0
  v_add_f32 v239, v239, v240
  v_sub_f32 v240, v223, v237
  v_mul_f32 v240, s70, v240
  v_exp_f32 v240, v240
  s_nop 0
  v_add_f32 v239, v239, v240
  v_sub_f32 v240, v225, v237
  v_mul_f32 v240, s70, v240
  v_exp_f32 v240, v240
  s_nop 0
  v_add_f32 v239, v239, v240
  v_sub_f32 v240, v227, v237
  v_mul_f32 v240, s70, v240
  v_exp_f32 v240, v240
  s_nop 0
  v_add_f32 v239, v239, v240
  v_sub_f32 v240, v229, v237
  v_mul_f32 v240, s70, v240
  v_exp_f32 v240, v240
  s_nop 0
  v_add_f32 v239, v239, v240
  v_sub_f32 v240, v231, v237
  v_mul_f32 v240, s70, v240
  v_exp_f32 v240, v240
  s_nop 0
  v_add_f32 v239, v239, v240
  s_nop 1
  v_add_f32_dpp v239, v239, v239 quad_perm:[1,0,3,2] row_mask:0xf bank_mask:0xf
  s_nop 1
  v_add_f32_dpp v239, v239, v239 quad_perm:[2,3,0,1] row_mask:0xf bank_mask:0xf
  s_nop 1
  v_add_f32_dpp v239, v239, v239 row_half_mirror row_mask:0xf bank_mask:0xf
  s_nop 1
  v_add_f32_dpp v239, v239, v239 row_mirror row_mask:0xf bank_mask:0xf
  v_mov_b32 v240, v239
  s_nop 1
  v_permlane16_swap_b32 v239, v240
  s_nop 1
  v_add_f32 v239, v239, v240
  v_mov_b32 v240, v239
  s_nop 1
  v_permlane32_swap_b32 v239, v240
  s_nop 1
  v_add_f32 v239, v239, v240
  v_mov_b32 v244, v236
  v_mov_b32 v245, v238
  v_mov_b32 v246, v237
  v_mov_b32 v247, v239
  s_lshl_b32 s64, s3, 4
  v_mov_b32 v240, s64
  s_mov_b64 exec, 1
  ds_write_b128 v240, v[244:247] offset:256
  ds_add_rtn_u32 v241, v2, v3 offset:12
  s_mov_b64 exec, -1
  s_waitcnt lgkmcnt(0)
  v_readfirstlane_b32 s64, v241
  s_cmp_eq_u32 s64, 3
  s_cbranch_scc0 L_s_mlnl
  s_mov_b32 s94, 4000000
L_lw_39:
  ds_read_b32 v241, v2 offset:4
  s_waitcnt lgkmcnt(0)
  v_readfirstlane_b32 s95, v241
  s_cmp_ge_u32 s95, 3
  s_cbranch_scc1 L_lwd_40
  s_sleep 1
  s_sub_u32 s94, s94, 1
  s_cmp_lg_u32 s94, 0
  s_cbranch_scc1 L_lw_39
  s_branch L_end
L_lwd_40:
  ds_read_b128 v[32:35], v2 offset:256
  ds_read_b128 v[36:39], v2 offset:272
  ds_read_b128 v[40:43], v2 offset:288
  ds_read_b128 v[44:47], v2 offset:304
  s_lshl_b32 s64, s38, 6
  s_add_u32 s64, s64, 65536
  s_waitcnt lgkmcnt(0)
  v_max_f32 v56, v32, v36
  v_max_f32 v56, v56, v40
  v_max_f32 v56, v56, v44
  v_sub_f32 v60, v32, v56
  v_mul_f32 v60, s70, v60
  v_exp_f32 v60, v60
  s_nop 0
  v_mul_f32 v58, v60, v33
  v_sub_f32 v60, v36, v56
  v_mul_f32 v60, s70, v60
  v_exp_f32 v60, v60
  s_nop 0
  v_fmac_f32 v58, v60, v37
  v_sub_f32 v60, v40, v56
  v_mul_f32 v60, s70, v60
  v_exp_f32 v60, v60
  s_nop 0
  v_fmac_f32 v58, v60, v41
  v_sub_f32 v60, v44, v56
  v_mul_f32 v60, s70, v60
  v_exp_f32 v60, v60
  s_nop 0
  v_fmac_f32 v58, v60, v45
  v_max_f32 v57, v34, v38
  v_max_f32 v57, v57, v42
  v_max_f32 v57, v57, v46
  v_sub_f32 v60, v34, v57
  v_mul_f32 v60, s70, v60
  v_exp_f32 v60, v60
  s_nop 0
  v_mul_f32 v59, v60, v35
  v_sub_f32 v60, v38, v57
  v_mul_f32 v60, s70, v60
  v_exp_f32 v60, v60
  s_nop 0
  v_fmac_f32 v59, v60, v39
  v_sub_f32 v60, v42, v57
  v_mul_f32 v60, s70, v60
  v_exp_f32 v60, v60
  s_nop 0
  v_fmac_f32 v59, v60, v43
  v_sub_f32 v60, v46, v57
  v_mul_f32 v60, s70, v60
  v_exp_f32 v60, v60
  s_nop 0
  v_fmac_f32 v59, v60, v47
  v_mov_b32 v48, v56
  v_mov_b32 v49, v58
  v_mov_b32 v50, v57
  v_mov_b32 v51, v59
  v_min_u32 v48, -2, v48
  v_min_u32 v49, -2, v49
  v_min_u32 v50, -2, v50
  v_min_u32 v51, -2, v51
  s_mov_b64 exec, 1
  buffer_store_dwordx4 v[48:51], v2, s[52:55], s64 offen sc1
  ds_write_b128 v2, v[48:51] offset:320
  ds_add_u32 v2, v3 offset:16
  s_mov_b64 exec, -1
L_s_mlnl:
  s_waitcnt vmcnt(4)
  buffer_load_dwordx4 v6, s[44:47], s67 offen offset:2048 nt lds
  s_waitcnt vmcnt(4)
  buffer_load_dwordx4 v6, s[44:47], s67 offen offset:3072 nt lds
  s_waitcnt vmcnt(4)
  s_add_u32 m0, s65, 0
  s_add_u32 s67, s66, 32768
  buffer_load_dwordx4 v5, s[44:47], s67 offen offset:0 nt lds
  s_waitcnt vmcnt(4)
  buffer_load_dwordx4 v5, s[44:47], s67 offen offset:1024 nt lds
  s_waitcnt vmcnt(4)
  buffer_load_dwordx4 v6, s[44:47], s67 offen offset:2048 nt lds
  s_waitcnt vmcnt(4)
  buffer_load_dwordx4 v6, s[44:47], s67 offen offset:3072 nt lds
  s_waitcnt vmcnt(4)
  s_add_u32 m0, s65, 4096
  s_add_u32 s67, s66, 49152
  buffer_load_dwordx4 v5, s[44:47], s67 offen offset:0 nt lds
  s_waitcnt vmcnt(4)
  buffer_load_dwordx4 v5, s[44:47], s67 offen offset:1024 nt lds
  s_waitcnt vmcnt(4)
  buffer_load_dwordx4 v6, s[44:47], s67 offen offset:2048 nt lds
  s_waitcnt vmcnt(4)
  buffer_load_dwordx4 v6, s[44:47], s67 offen offset:3072 nt lds
  s_add_u32 m0, s65, 8192
  s_add_u32 s67, s66, 65536
  buffer_load_dwordx4 v5, s[44:47], s67 offen offset:0 nt lds
  s_waitcnt vmcnt(5)
  buffer_load_dwordx4 v5, s[44:47], s67 offen offset:1024 nt lds
  s_waitcnt vmcnt(5)
  buffer_load_dwordx4 v6, s[44:47], s67 offen offset:2048 nt lds
  s_waitcnt vmcnt(5)
  buffer_load_dwordx4 v6, s[44:47], s67 offen offset:3072 nt lds
  s_waitcnt vmcnt(5)
  s_add_u32 m0, s65, 12288
  s_add_u32 s67, s66, 81920
  buffer_load_dwordx4 v5, s[44:47], s67 offen offset:0 nt lds
  s_waitcnt vmcnt(5)
  buffer_load_dwordx4 v5, s[44:47], s67 offen offset:1024 nt lds
  s_waitcnt vmcnt(5)
  buffer_load_dwordx4 v6, s[44:47], s67 offen offset:2048 nt lds
  s_waitcnt vmcnt(5)
  buffer_load_dwordx4 v6, s[44:47], s67 offen offset:3072 nt lds
  s_mov_b32 s94, 4000000
L_lw_41:
  ds_read_b32 v232, v2 offset:44
  s_waitcnt lgkmcnt(0)
  v_readfirstlane_b32 s95, v232
  s_cmp_ge_u32 s95, 1
  s_cbranch_scc1 L_lwd_42
  s_sleep 1
  s_sub_u32 s94, s94, 1
  s_cmp_lg_u32 s94, 0
  s_cbranch_scc1 L_lw_41
  s_branch L_end
L_lwd_42:
  s_lshl_b32 s64, s38, 6
  s_add_u32 s64, s64, 65536
  s_xor_b32 s64, s64, 64
  s_mov_b32 s94, 400000
L_ml_43:
  buffer_load_dwordx4 v[36:39], v2, s[52:55], s64 offen sc1
  s_waitcnt vmcnt(0)
  v_max3_u32 v232, v36, v37, v38
  v_max_u32 v232, v232, v39
  v_cmp_eq_u32 vcc, -1, v232
  s_cmp_eq_u64 vcc, 0
  s_cbranch_scc1 L_mld_44
  s_sleep 1
  s_sub_u32 s94, s94, 1
  s_cmp_lg_u32 s94, 0
  s_cbranch_scc1 L_ml_43
  s_branch L_end
L_mld_44:
  s_mov_b32 s94, 4000000
L_lw_45:
  ds_read_b32 v232, v2 offset:16
  s_waitcnt lgkmcnt(0)
  v_readfirstlane_b32 s95, v232
  s_cmp_ge_u32 s95, 1
  s_cbranch_scc1 L_lwd_46
  s_sleep 1
  s_sub_u32 s94, s94, 1
  s_cmp_lg_u32 s94, 0
  s_cbranch_scc1 L_lw_45
  s_branch L_end
L_lwd_46:
  ds_read_b128 v[32:35], v2 offset:320
  s_cmp_eq_u32 s32, 0
  s_cselect_b64 vcc, -1, 0
  s_waitcnt lgkmcnt(0)
  v_cndmask_b32 v40, v36, v32, vcc
  v_cndmask_b32 v44, v32, v36, vcc
  v_cndmask_b32 v41, v37, v33, vcc
  v_cndmask_b32 v45, v33, v37, vcc
  v_cndmask_b32 v42, v38, v34, vcc
  v_cndmask_b32 v46, v34, v38, vcc
  v_cndmask_b32 v43, v39, v35, vcc
  v_cndmask_b32 v47, v35, v39, vcc
  v_max_f32 v56, v40, v44
  v_sub_f32 v60, v40, v56
  v_mul_f32 v60, s70, v60
  v_exp_f32 v60, v60
  s_nop 0
  v_mul_f32 v58, v60, v41
  v_sub_f32 v60, v44, v56
  v_mul_f32 v60, s70, v60
  v_exp_f32 v60, v60
  s_nop 0
  v_fmac_f32 v58, v60, v45
  v_max_f32 v57, v42, v46
  v_sub_f32 v60, v42, v57
  v_mul_f32 v60, s70, v60
  v_exp_f32 v60, v60
  s_nop 0
  v_mul_f32 v59, v60, v43
  v_sub_f32 v60, v46, v57
  v_mul_f32 v60, s70, v60
  v_exp_f32 v60, v60
  s_nop 0
  v_fmac_f32 v59, v60, v47
  v_mov_b32 v244, v56
  v_mov_b32 v245, v58
  v_mov_b32 v246, v57
  v_mov_b32 v247, v59
  v_rcp_f32 v232, v245
  s_nop 0
  v_fma_f32 v233, -v245, v232, 1.0
  v_fma_f32 v245, v233, v232, v232
  v_rcp_f32 v232, v247
  s_nop 0
  v_fma_f32 v233, -v247, v232, 1.0
  v_fma_f32 v247, v233, v232, v232
  s_mul_i32 s64, s3, 2048
  s_add_u32 s64, s64, 19712
  v_lshl_add_u32 v241, v1, 1, s64
  v_sub_f32 v232, v216, v244
  v_mul_f32 v232, s70, v232
  v_exp_f32 v232, v232
  v_sub_f32 v233, v217, v246
  v_mul_f32 v233, s70, v233
  v_exp_f32 v233, v233
  s_nop 0
  v_mul_f32 v232, v232, v245
  v_mul_f32 v233, v233, v247
  v_cvt_pk_bf16_f32 v234, v232, v233
  ds_write_b16 v241, v234 offset:0
  ds_write_b16_d16_hi v241, v234 offset:1024
  v_sub_f32 v232, v218, v244
  v_mul_f32 v232, s70, v232
  v_exp_f32 v232, v232
  v_sub_f32 v233, v219, v246
  v_mul_f32 v233, s70, v233
  v_exp_f32 v233, v233
  s_nop 0
  v_mul_f32 v232, v232, v245
  v_mul_f32 v233, v233, v247
  v_cvt_pk_bf16_f32 v235, v232, v233
  ds_write_b16 v241, v235 offset:128
  ds_write_b16_d16_hi v241, v235 offset:1152
  v_sub_f32 v232, v220, v244
  v_mul_f32 v232, s70, v232
  v_exp_f32 v232, v232
  v_sub_f32 v233, v221, v246
  v_mul_f32 v233, s70, v233
  v_exp_f32 v233, v233
  s_nop 0
  v_mul_f32 v232, v232, v245
  v_mul_f32 v233, v233, v247
  v_cvt_pk_bf16_f32 v234, v232, v233
  ds_write_b16 v241, v234 offset:256
  ds_write_b16_d16_hi v241, v234 offset:1280
  v_sub_f32 v232, v222, v244
  v_mul_f32 v232, s70, v232
  v_exp_f32 v232, v232
  v_sub_f32 v233, v223, v246
  v_mul_f32 v233, s70, v233
  v_exp_f32 v233, v233
  s_nop 0
  v_mul_f32 v232, v232, v245
  v_mul_f32 v233, v233, v247
  v_cvt_pk_bf16_f32 v235, v232, v233
  ds_write_b16 v241, v235 offset:384
  ds_write_b16_d16_hi v241, v235 offset:1408
  v_sub_f32 v232, v224, v244
  v_mul_f32 v232, s70, v232
  v_exp_f32 v232, v232
  v_sub_f32 v233, v225, v246
  v_mul_f32 v233, s70, v233
  v_exp_f32 v233, v233
  s_nop 0
  v_mul_f32 v232, v232, v245
  v_mul_f32 v233, v233, v247
  v_cvt_pk_bf16_f32 v234, v232, v233
  ds_write_b16 v241, v234 offset:512
  ds_write_b16_d16_hi v241, v234 offset:1536
  v_sub_f32 v232, v226, v244
  v_mul_f32 v232, s70, v232
  v_exp_f32 v232, v232
  v_sub_f32 v233, v227, v246
  v_mul_f32 v233, s70, v233
  v_exp_f32 v233, v233
  s_nop 0
  v_mul_f32 v232, v232, v245
  v_mul_f32 v233, v233, v247
  v_cvt_pk_bf16_f32 v235, v232, v233
  ds_write_b16 v241, v235 offset:640
  ds_write_b16_d16_hi v241, v235 offset:1664
  v_sub_f32 v232, v228, v244
  v_mul_f32 v232, s70, v232
  v_exp_f32 v232, v232
  v_sub_f32 v233, v229, v246
  v_mul_f32 v233, s70, v233
  v_exp_f32 v233, v233
  s_nop 0
  v_mul_f32 v232, v232, v245
  v_mul_f32 v233, v233, v247
  v_cvt_pk_bf16_f32 v234, v232, v233
  ds_write_b16 v241, v234 offset:768
  ds_write_b16_d16_hi v241, v234 offset:1792
  v_sub_f32 v232, v230, v244
  v_mul_f32 v232, s70, v232
  v_exp_f32 v232, v232
  v_sub_f32 v233, v231, v246
  v_mul_f32 v233, s70, v233
  v_exp_f32 v233, v233
  s_nop 0
  v_mul_f32 v232, v232, v245
  v_mul_f32 v233, v233, v247
  v_cvt_pk_bf16_f32 v235, v232, v233
  ds_write_b16 v241, v235 offset:896
  ds_write_b16_d16_hi v241, v235 offset:1920
  s_waitcnt lgkmcnt(0)
  ds_read_b128 v[192:195], v30 offset:0
  ds_read_b64_tr_b16 v[128:129], v14 offset:16384
  ds_read_b64_tr_b16 v[130:131], v15 offset:16384
  ds_read_b64_tr_b16 v[132:133], v16 offset:16384
  ds_read_b64_tr_b16 v[134:135], v17 offset:16384
  ds_read_b64_tr_b16 v[136:137], v18 offset:16384
  ds_read_b64_tr_b16 v[138:139], v19 offset:16384
  ds_read_b64_tr_b16 v[140:141], v20 offset:16384
  ds_read_b64_tr_b16 v[142:143], v21 offset:16384
  s_waitcnt lgkmcnt(6)
  v_mfma_f32_16x16x32_bf16 v[160:163], v[128:131], v[192:195], 0
  s_waitcnt lgkmcnt(4)
  v_mfma_f32_16x16x32_bf16 v[164:167], v[132:135], v[192:195], 0
  s_waitcnt lgkmcnt(2)
  v_mfma_f32_16x16x32_bf16 v[168:171], v[136:139], v[192:195], 0
  s_waitcnt lgkmcnt(0)
  v_mfma_f32_16x16x32_bf16 v[172:175], v[140:143], v[192:195], 0
  ds_read_b64_tr_b16 v[144:145], v22 offset:16384
  ds_read_b64_tr_b16 v[146:147], v23 offset:16384
  ds_read_b64_tr_b16 v[148:149], v24 offset:16384
  ds_read_b64_tr_b16 v[150:151], v25 offset:16384
  ds_read_b64_tr_b16 v[152:153], v26 offset:16384
  ds_read_b64_tr_b16 v[154:155], v27 offset:16384
  ds_read_b64_tr_b16 v[156:157], v28 offset:16384
  ds_read_b64_tr_b16 v[158:159], v29 offset:16384
  s_waitcnt lgkmcnt(6)
  v_mfma_f32_16x16x32_bf16 v[176:179], v[144:147], v[192:195], 0
  s_waitcnt lgkmcnt(4)
  v_mfma_f32_16x16x32_bf16 v[180:183], v[148:151], v[192:195], 0
  s_waitcnt lgkmcnt(2)
  v_mfma_f32_16x16x32_bf16 v[184:187], v[152:155], v[192:195], 0
  s_waitcnt lgkmcnt(0)
  v_mfma_f32_16x16x32_bf16 v[188:191], v[156:159], v[192:195], 0
  s_waitcnt vmcnt(5)
  s_add_u32 m0, s65, 16384
  s_add_u32 s67, s66, 98304
  buffer_load_dwordx4 v5, s[44:47], s67 offen offset:0 nt lds
  ds_read_b128 v[192:195], v30 offset:64
  ds_read_b64_tr_b16 v[128:129], v14 offset:0
  ds_read_b64_tr_b16 v[130:131], v15 offset:0
  ds_read_b64_tr_b16 v[132:133], v16 offset:0
  ds_read_b64_tr_b16 v[134:135], v17 offset:0
  ds_read_b64_tr_b16 v[136:137], v18 offset:0
  ds_read_b64_tr_b16 v[138:139], v19 offset:0
  ds_read_b64_tr_b16 v[140:141], v20 offset:0
  ds_read_b64_tr_b16 v[142:143], v21 offset:0
  s_waitcnt lgkmcnt(6)
  v_mfma_f32_16x16x32_bf16 v[160:163], v[128:131], v[192:195], v[160:163]
  s_waitcnt lgkmcnt(4)
  v_mfma_f32_16x16x32_bf16 v[164:167], v[132:135], v[192:195], v[164:167]
  s_waitcnt lgkmcnt(2)
  v_mfma_f32_16x16x32_bf16 v[168:171], v[136:139], v[192:195], v[168:171]
  s_waitcnt lgkmcnt(0)
  v_mfma_f32_16x16x32_bf16 v[172:175], v[140:143], v[192:195], v[172:175]
  ds_read_b64_tr_b16 v[144:145], v22 offset:0
  ds_read_b64_tr_b16 v[146:147], v23 offset:0
  ds_read_b64_tr_b16 v[148:149], v24 offset:0
  ds_read_b64_tr_b16 v[150:151], v25 offset:0
  ds_read_b64_tr_b16 v[152:153], v26 offset:0
  ds_read_b64_tr_b16 v[154:155], v27 offset:0
  ds_read_b64_tr_b16 v[156:157], v28 offset:0
  ds_read_b64_tr_b16 v[158:159], v29 offset:0
  s_waitcnt lgkmcnt(6)
  v_mfma_f32_16x16x32_bf16 v[176:179], v[144:147], v[192:195], v[176:179]
  s_waitcnt lgkmcnt(4)
  v_mfma_f32_16x16x32_bf16 v[180:183], v[148:151], v[192:195], v[180:183]
  s_waitcnt lgkmcnt(2)
  v_mfma_f32_16x16x32_bf16 v[184:187], v[152:155], v[192:195], v[184:187]
  s_waitcnt lgkmcnt(0)
  v_mfma_f32_16x16x32_bf16 v[188:191], v[156:159], v[192:195], v[188:191]
  s_waitcnt vmcnt(5)
  buffer_load_dwordx4 v5, s[44:47], s67 offen offset:1024 nt lds
  s_waitcnt vmcnt(5)
  buffer_load_dwordx4 v6, s[44:47], s67 offen offset:2048 nt lds
  s_waitcnt vmcnt(5)
  buffer_load_dwordx4 v6, s[44:47], s67 offen offset:3072 nt lds
  s_waitcnt vmcnt(5)
  s_add_u32 m0, s65, 20480
  s_add_u32 s67, s66, 114688
  buffer_load_dwordx4 v5, s[44:47], s67 offen offset:0 nt lds
  s_waitcnt vmcnt(5)
  buffer_load_dwordx4 v5, s[44:47], s67 offen offset:1024 nt lds
  ds_read_b128 v[192:195], v30 offset:128
  ds_read_b64_tr_b16 v[128:129], v14 offset:8192
  ds_read_b64_tr_b16 v[130:131], v15 offset:8192
  ds_read_b64_tr_b16 v[132:133], v16 offset:8192
  ds_read_b64_tr_b16 v[134:135], v17 offset:8192
  ds_read_b64_tr_b16 v[136:137], v18 offset:8192
  ds_read_b64_tr_b16 v[138:139], v19 offset:8192
  ds_read_b64_tr_b16 v[140:141], v20 offset:8192
  ds_read_b64_tr_b16 v[142:143], v21 offset:8192
  s_waitcnt lgkmcnt(6)
  v_mfma_f32_16x16x32_bf16 v[160:163], v[128:131], v[192:195], v[160:163]
  s_waitcnt lgkmcnt(4)
  v_mfma_f32_16x16x32_bf16 v[164:167], v[132:135], v[192:195], v[164:167]
  s_waitcnt lgkmcnt(2)
  v_mfma_f32_16x16x32_bf16 v[168:171], v[136:139], v[192:195], v[168:171]
  s_waitcnt lgkmcnt(0)
  v_mfma_f32_16x16x32_bf16 v[172:175], v[140:143], v[192:195], v[172:175]
  ds_read_b64_tr_b16 v[144:145], v22 offset:8192
  ds_read_b64_tr_b16 v[146:147], v23 offset:8192
  ds_read_b64_tr_b16 v[148:149], v24 offset:8192
  ds_read_b64_tr_b16 v[150:151], v25 offset:8192
  ds_read_b64_tr_b16 v[152:153], v26 offset:8192
  ds_read_b64_tr_b16 v[154:155], v27 offset:8192
  ds_read_b64_tr_b16 v[156:157], v28 offset:8192
  ds_read_b64_tr_b16 v[158:159], v29 offset:8192
  s_waitcnt lgkmcnt(6)
  v_mfma_f32_16x16x32_bf16 v[176:179], v[144:147], v[192:195], v[176:179]
  s_waitcnt lgkmcnt(4)
  v_mfma_f32_16x16x32_bf16 v[180:183], v[148:151], v[192:195], v[180:183]
  s_waitcnt lgkmcnt(2)
  v_mfma_f32_16x16x32_bf16 v[184:187], v[152:155], v[192:195], v[184:187]
  s_waitcnt lgkmcnt(0)
  v_mfma_f32_16x16x32_bf16 v[188:191], v[156:159], v[192:195], v[188:191]
  s_waitcnt vmcnt(5)
  buffer_load_dwordx4 v6, s[44:47], s67 offen offset:2048 nt lds
  s_waitcnt vmcnt(5)
  buffer_load_dwordx4 v6, s[44:47], s67 offen offset:3072 nt lds
  s_waitcnt vmcnt(5)
  s_add_u32 m0, s65, 0
  s_add_u32 s67, s66, 131072
  buffer_load_dwordx4 v5, s[44:47], s67 offen offset:0 nt lds
  s_waitcnt vmcnt(5)
  buffer_load_dwordx4 v5, s[44:47], s67 offen offset:1024 nt lds
  s_waitcnt vmcnt(5)
  buffer_load_dwordx4 v6, s[44:47], s67 offen offset:2048 nt lds
  s_waitcnt vmcnt(5)
  buffer_load_dwordx4 v6, s[44:47], s67 offen offset:3072 nt lds
  s_waitcnt vmcnt(5)
  s_add_u32 m0, s65, 4096
  s_add_u32 s67, s66, 147456
  buffer_load_dwordx4 v5, s[44:47], s67 offen offset:0 nt lds
  s_waitcnt vmcnt(5)
  buffer_load_dwordx4 v5, s[44:47], s67 offen offset:1024 nt lds
  ds_read_b128 v[192:195], v30 offset:192
  ds_read_b64_tr_b16 v[128:129], v14 offset:16384
  ds_read_b64_tr_b16 v[130:131], v15 offset:16384
  ds_read_b64_tr_b16 v[132:133], v16 offset:16384
  ds_read_b64_tr_b16 v[134:135], v17 offset:16384
  ds_read_b64_tr_b16 v[136:137], v18 offset:16384
  ds_read_b64_tr_b16 v[138:139], v19 offset:16384
  ds_read_b64_tr_b16 v[140:141], v20 offset:16384
  ds_read_b64_tr_b16 v[142:143], v21 offset:16384
  s_waitcnt lgkmcnt(6)
  v_mfma_f32_16x16x32_bf16 v[160:163], v[128:131], v[192:195], v[160:163]
  s_waitcnt lgkmcnt(4)
  v_mfma_f32_16x16x32_bf16 v[164:167], v[132:135], v[192:195], v[164:167]
  s_waitcnt lgkmcnt(2)
  v_mfma_f32_16x16x32_bf16 v[168:171], v[136:139], v[192:195], v[168:171]
  s_waitcnt lgkmcnt(0)
  v_mfma_f32_16x16x32_bf16 v[172:175], v[140:143], v[192:195], v[172:175]
  ds_read_b64_tr_b16 v[144:145], v22 offset:16384
  ds_read_b64_tr_b16 v[146:147], v23 offset:16384
  ds_read_b64_tr_b16 v[148:149], v24 offset:16384
  ds_read_b64_tr_b16 v[150:151], v25 offset:16384
  ds_read_b64_tr_b16 v[152:153], v26 offset:16384
  ds_read_b64_tr_b16 v[154:155], v27 offset:16384
  ds_read_b64_tr_b16 v[156:157], v28 offset:16384
  ds_read_b64_tr_b16 v[158:159], v29 offset:16384
  s_waitcnt lgkmcnt(6)
  v_mfma_f32_16x16x32_bf16 v[176:179], v[144:147], v[192:195], v[176:179]
  s_waitcnt lgkmcnt(4)
  v_mfma_f32_16x16x32_bf16 v[180:183], v[148:151], v[192:195], v[180:183]
  s_waitcnt lgkmcnt(2)
  v_mfma_f32_16x16x32_bf16 v[184:187], v[152:155], v[192:195], v[184:187]
  s_waitcnt lgkmcnt(0)
  v_mfma_f32_16x16x32_bf16 v[188:191], v[156:159], v[192:195], v[188:191]
  s_waitcnt vmcnt(5)
  buffer_load_dwordx4 v6, s[44:47], s67 offen offset:2048 nt lds
  s_waitcnt vmcnt(5)
  buffer_load_dwordx4 v6, s[44:47], s67 offen offset:3072 nt lds
  s_waitcnt vmcnt(5)
  s_add_u32 m0, s65, 8192
  s_add_u32 s67, s66, 163840
  buffer_load_dwordx4 v5, s[44:47], s67 offen offset:0 nt lds
  s_waitcnt vmcnt(5)
  buffer_load_dwordx4 v5, s[44:47], s67 offen offset:1024 nt lds
  s_waitcnt vmcnt(5)
  buffer_load_dwordx4 v6, s[44:47], s67 offen offset:2048 nt lds
  s_waitcnt vmcnt(5)
  buffer_load_dwordx4 v6, s[44:47], s67 offen offset:3072 nt lds
  s_waitcnt vmcnt(5)
  s_add_u32 m0, s65, 12288
  s_add_u32 s67, s66, 180224
  buffer_load_dwordx4 v5, s[44:47], s67 offen offset:0 nt lds
  s_waitcnt vmcnt(5)
  buffer_load_dwordx4 v5, s[44:47], s67 offen offset:1024 nt lds
  ds_read_b128 v[192:195], v30 offset:256
  ds_read_b64_tr_b16 v[128:129], v14 offset:0
  ds_read_b64_tr_b16 v[130:131], v15 offset:0
  ds_read_b64_tr_b16 v[132:133], v16 offset:0
  ds_read_b64_tr_b16 v[134:135], v17 offset:0
  ds_read_b64_tr_b16 v[136:137], v18 offset:0
  ds_read_b64_tr_b16 v[138:139], v19 offset:0
  ds_read_b64_tr_b16 v[140:141], v20 offset:0
  ds_read_b64_tr_b16 v[142:143], v21 offset:0
  s_waitcnt lgkmcnt(6)
  v_mfma_f32_16x16x32_bf16 v[160:163], v[128:131], v[192:195], v[160:163]
  s_waitcnt lgkmcnt(4)
  v_mfma_f32_16x16x32_bf16 v[164:167], v[132:135], v[192:195], v[164:167]
  s_waitcnt lgkmcnt(2)
  v_mfma_f32_16x16x32_bf16 v[168:171], v[136:139], v[192:195], v[168:171]
  s_waitcnt lgkmcnt(0)
  v_mfma_f32_16x16x32_bf16 v[172:175], v[140:143], v[192:195], v[172:175]
  ds_read_b64_tr_b16 v[144:145], v22 offset:0
  ds_read_b64_tr_b16 v[146:147], v23 offset:0
  ds_read_b64_tr_b16 v[148:149], v24 offset:0
  ds_read_b64_tr_b16 v[150:151], v25 offset:0
  ds_read_b64_tr_b16 v[152:153], v26 offset:0
  ds_read_b64_tr_b16 v[154:155], v27 offset:0
  ds_read_b64_tr_b16 v[156:157], v28 offset:0
  ds_read_b64_tr_b16 v[158:159], v29 offset:0
  s_waitcnt lgkmcnt(6)
  v_mfma_f32_16x16x32_bf16 v[176:179], v[144:147], v[192:195], v[176:179]
  s_waitcnt lgkmcnt(4)
  v_mfma_f32_16x16x32_bf16 v[180:183], v[148:151], v[192:195], v[180:183]
  s_waitcnt lgkmcnt(2)
  v_mfma_f32_16x16x32_bf16 v[184:187], v[152:155], v[192:195], v[184:187]
  s_waitcnt lgkmcnt(0)
  v_mfma_f32_16x16x32_bf16 v[188:191], v[156:159], v[192:195], v[188:191]
  s_waitcnt vmcnt(5)
  buffer_load_dwordx4 v6, s[44:47], s67 offen offset:2048 nt lds
  s_waitcnt vmcnt(5)
  buffer_load_dwordx4 v6, s[44:47], s67 offen offset:3072 nt lds
  s_waitcnt vmcnt(5)
  s_add_u32 m0, s65, 16384
  s_add_u32 s67, s66, 196608
  buffer_load_dwordx4 v5, s[44:47], s67 offen offset:0 nt lds
  s_waitcnt vmcnt(5)
  buffer_load_dwordx4 v5, s[44:47], s67 offen offset:1024 nt lds
  s_waitcnt vmcnt(5)
  buffer_load_dwordx4 v6, s[44:47], s67 offen offset:2048 nt lds
  s_waitcnt vmcnt(5)
  buffer_load_dwordx4 v6, s[44:47], s67 offen offset:3072 nt lds
  s_waitcnt vmcnt(5)
  s_add_u32 m0, s65, 20480
  s_add_u32 s67, s66, 212992
  buffer_load_dwordx4 v5, s[44:47], s67 offen offset:0 nt lds
  s_waitcnt vmcnt(5)
  buffer_load_dwordx4 v5, s[44:47], s67 offen offset:1024 nt lds
  ds_read_b128 v[192:195], v30 offset:320
  ds_read_b64_tr_b16 v[128:129], v14 offset:8192
  ds_read_b64_tr_b16 v[130:131], v15 offset:8192
  ds_read_b64_tr_b16 v[132:133], v16 offset:8192
  ds_read_b64_tr_b16 v[134:135], v17 offset:8192
  ds_read_b64_tr_b16 v[136:137], v18 offset:8192
  ds_read_b64_tr_b16 v[138:139], v19 offset:8192
  ds_read_b64_tr_b16 v[140:141], v20 offset:8192
  ds_read_b64_tr_b16 v[142:143], v21 offset:8192
  s_waitcnt lgkmcnt(6)
  v_mfma_f32_16x16x32_bf16 v[160:163], v[128:131], v[192:195], v[160:163]
  s_waitcnt lgkmcnt(4)
  v_mfma_f32_16x16x32_bf16 v[164:167], v[132:135], v[192:195], v[164:167]
  s_waitcnt lgkmcnt(2)
  v_mfma_f32_16x16x32_bf16 v[168:171], v[136:139], v[192:195], v[168:171]
  s_waitcnt lgkmcnt(0)
  v_mfma_f32_16x16x32_bf16 v[172:175], v[140:143], v[192:195], v[172:175]
  ds_read_b64_tr_b16 v[144:145], v22 offset:8192
  ds_read_b64_tr_b16 v[146:147], v23 offset:8192
  ds_read_b64_tr_b16 v[148:149], v24 offset:8192
  ds_read_b64_tr_b16 v[150:151], v25 offset:8192
  ds_read_b64_tr_b16 v[152:153], v26 offset:8192
  ds_read_b64_tr_b16 v[154:155], v27 offset:8192
  ds_read_b64_tr_b16 v[156:157], v28 offset:8192
  ds_read_b64_tr_b16 v[158:159], v29 offset:8192
  s_waitcnt lgkmcnt(6)
  v_mfma_f32_16x16x32_bf16 v[176:179], v[144:147], v[192:195], v[176:179]
  s_waitcnt lgkmcnt(4)
  v_mfma_f32_16x16x32_bf16 v[180:183], v[148:151], v[192:195], v[180:183]
  s_waitcnt lgkmcnt(2)
  v_mfma_f32_16x16x32_bf16 v[184:187], v[152:155], v[192:195], v[184:187]
  s_waitcnt lgkmcnt(0)
  v_mfma_f32_16x16x32_bf16 v[188:191], v[156:159], v[192:195], v[188:191]
  s_waitcnt vmcnt(5)
  buffer_load_dwordx4 v6, s[44:47], s67 offen offset:2048 nt lds
  s_waitcnt vmcnt(5)
  buffer_load_dwordx4 v6, s[44:47], s67 offen offset:3072 nt lds
  s_waitcnt vmcnt(5)
  s_add_u32 m0, s65, 0
  s_add_u32 s67, s66, 229376
  buffer_load_dwordx4 v5, s[44:47], s67 offen offset:0 nt lds
  s_waitcnt vmcnt(5)
  buffer_load_dwordx4 v5, s[44:47], s67 offen offset:1024 nt lds
  s_waitcnt vmcnt(5)
  buffer_load_dwordx4 v6, s[44:47], s67 offen offset:2048 nt lds
  s_waitcnt vmcnt(5)
  buffer_load_dwordx4 v6, s[44:47], s67 offen offset:3072 nt lds
  s_waitcnt vmcnt(5)
  s_add_u32 m0, s65, 4096
  s_add_u32 s67, s66, 245760
  buffer_load_dwordx4 v5, s[44:47], s67 offen offset:0 nt lds
  s_waitcnt vmcnt(5)
  buffer_load_dwordx4 v5, s[44:47], s67 offen offset:1024 nt lds
  ds_read_b128 v[192:195], v30 offset:384
  ds_read_b64_tr_b16 v[128:129], v14 offset:16384
  ds_read_b64_tr_b16 v[130:131], v15 offset:16384
  ds_read_b64_tr_b16 v[132:133], v16 offset:16384
  ds_read_b64_tr_b16 v[134:135], v17 offset:16384
  ds_read_b64_tr_b16 v[136:137], v18 offset:16384
  ds_read_b64_tr_b16 v[138:139], v19 offset:16384
  ds_read_b64_tr_b16 v[140:141], v20 offset:16384
  ds_read_b64_tr_b16 v[142:143], v21 offset:16384
  s_waitcnt lgkmcnt(6)
  v_mfma_f32_16x16x32_bf16 v[160:163], v[128:131], v[192:195], v[160:163]
  s_waitcnt lgkmcnt(4)
  v_mfma_f32_16x16x32_bf16 v[164:167], v[132:135], v[192:195], v[164:167]
  s_waitcnt lgkmcnt(2)
  v_mfma_f32_16x16x32_bf16 v[168:171], v[136:139], v[192:195], v[168:171]
  s_waitcnt lgkmcnt(0)
  v_mfma_f32_16x16x32_bf16 v[172:175], v[140:143], v[192:195], v[172:175]
  ds_read_b64_tr_b16 v[144:145], v22 offset:16384
  ds_read_b64_tr_b16 v[146:147], v23 offset:16384
  ds_read_b64_tr_b16 v[148:149], v24 offset:16384
  ds_read_b64_tr_b16 v[150:151], v25 offset:16384
  ds_read_b64_tr_b16 v[152:153], v26 offset:16384
  ds_read_b64_tr_b16 v[154:155], v27 offset:16384
  ds_read_b64_tr_b16 v[156:157], v28 offset:16384
  ds_read_b64_tr_b16 v[158:159], v29 offset:16384
  s_waitcnt lgkmcnt(6)
  v_mfma_f32_16x16x32_bf16 v[176:179], v[144:147], v[192:195], v[176:179]
  s_waitcnt lgkmcnt(4)
  v_mfma_f32_16x16x32_bf16 v[180:183], v[148:151], v[192:195], v[180:183]
  s_waitcnt lgkmcnt(2)
  v_mfma_f32_16x16x32_bf16 v[184:187], v[152:155], v[192:195], v[184:187]
  s_waitcnt lgkmcnt(0)
  v_mfma_f32_16x16x32_bf16 v[188:191], v[156:159], v[192:195], v[188:191]
  s_waitcnt vmcnt(5)
  buffer_load_dwordx4 v6, s[44:47], s67 offen offset:2048 nt lds
  s_waitcnt vmcnt(5)
  buffer_load_dwordx4 v6, s[44:47], s67 offen offset:3072 nt lds
  s_waitcnt vmcnt(5)
  s_add_u32 m0, s65, 8192
  s_add_u32 s67, s66, 262144
  buffer_load_dwordx4 v5, s[44:47], s67 offen offset:0 nt lds
  s_waitcnt vmcnt(5)
  buffer_load_dwordx4 v5, s[44:47], s67 offen offset:1024 nt lds
  s_waitcnt vmcnt(5)
  buffer_load_dwordx4 v6, s[44:47], s67 offen offset:2048 nt lds
  s_waitcnt vmcnt(5)
  buffer_load_dwordx4 v6, s[44:47], s67 offen offset:3072 nt lds
  s_waitcnt vmcnt(5)
  s_add_u32 m0, s65, 12288
  s_add_u32 s67, s66, 278528
  buffer_load_dwordx4 v5, s[44:47], s67 offen offset:0 nt lds
  s_waitcnt vmcnt(5)
  buffer_load_dwordx4 v5, s[44:47], s67 offen offset:1024 nt lds
  ds_read_b128 v[192:195], v30 offset:448
  ds_read_b64_tr_b16 v[128:129], v14 offset:0
  ds_read_b64_tr_b16 v[130:131], v15 offset:0
  ds_read_b64_tr_b16 v[132:133], v16 offset:0
  ds_read_b64_tr_b16 v[134:135], v17 offset:0
  ds_read_b64_tr_b16 v[136:137], v18 offset:0
  ds_read_b64_tr_b16 v[138:139], v19 offset:0
  ds_read_b64_tr_b16 v[140:141], v20 offset:0
  ds_read_b64_tr_b16 v[142:143], v21 offset:0
  s_waitcnt lgkmcnt(6)
  v_mfma_f32_16x16x32_bf16 v[160:163], v[128:131], v[192:195], v[160:163]
  s_waitcnt lgkmcnt(4)
  v_mfma_f32_16x16x32_bf16 v[164:167], v[132:135], v[192:195], v[164:167]
  s_waitcnt lgkmcnt(2)
  v_mfma_f32_16x16x32_bf16 v[168:171], v[136:139], v[192:195], v[168:171]
  s_waitcnt lgkmcnt(0)
  v_mfma_f32_16x16x32_bf16 v[172:175], v[140:143], v[192:195], v[172:175]
  ds_read_b64_tr_b16 v[144:145], v22 offset:0
  ds_read_b64_tr_b16 v[146:147], v23 offset:0
  ds_read_b64_tr_b16 v[148:149], v24 offset:0
  ds_read_b64_tr_b16 v[150:151], v25 offset:0
  ds_read_b64_tr_b16 v[152:153], v26 offset:0
  ds_read_b64_tr_b16 v[154:155], v27 offset:0
  ds_read_b64_tr_b16 v[156:157], v28 offset:0
  ds_read_b64_tr_b16 v[158:159], v29 offset:0
  s_waitcnt lgkmcnt(6)
  v_mfma_f32_16x16x32_bf16 v[176:179], v[144:147], v[192:195], v[176:179]
  s_waitcnt lgkmcnt(4)
  v_mfma_f32_16x16x32_bf16 v[180:183], v[148:151], v[192:195], v[180:183]
  s_waitcnt lgkmcnt(2)
  v_mfma_f32_16x16x32_bf16 v[184:187], v[152:155], v[192:195], v[184:187]
  s_waitcnt lgkmcnt(0)
  v_mfma_f32_16x16x32_bf16 v[188:191], v[156:159], v[192:195], v[188:191]
  s_waitcnt vmcnt(5)
  buffer_load_dwordx4 v6, s[44:47], s67 offen offset:2048 nt lds
  s_waitcnt vmcnt(5)
  buffer_load_dwordx4 v6, s[44:47], s67 offen offset:3072 nt lds
  s_waitcnt vmcnt(5)
  s_add_u32 m0, s65, 16384
  s_add_u32 s67, s66, 294912
  buffer_load_dwordx4 v5, s[44:47], s67 offen offset:0 nt lds
  s_waitcnt vmcnt(5)
  buffer_load_dwordx4 v5, s[44:47], s67 offen offset:1024 nt lds
  s_waitcnt vmcnt(5)
  buffer_load_dwordx4 v6, s[44:47], s67 offen offset:2048 nt lds
  s_waitcnt vmcnt(5)
  buffer_load_dwordx4 v6, s[44:47], s67 offen offset:3072 nt lds
  s_waitcnt vmcnt(5)
  s_add_u32 m0, s65, 20480
  s_add_u32 s67, s66, 311296
  buffer_load_dwordx4 v5, s[44:47], s67 offen offset:0 nt lds
  s_waitcnt vmcnt(5)
  buffer_load_dwordx4 v5, s[44:47], s67 offen offset:1024 nt lds
  ds_read_b128 v[192:195], v30 offset:512
  ds_read_b64_tr_b16 v[128:129], v14 offset:8192
  ds_read_b64_tr_b16 v[130:131], v15 offset:8192
  ds_read_b64_tr_b16 v[132:133], v16 offset:8192
  ds_read_b64_tr_b16 v[134:135], v17 offset:8192
  ds_read_b64_tr_b16 v[136:137], v18 offset:8192
  ds_read_b64_tr_b16 v[138:139], v19 offset:8192
  ds_read_b64_tr_b16 v[140:141], v20 offset:8192
  ds_read_b64_tr_b16 v[142:143], v21 offset:8192
  s_waitcnt lgkmcnt(6)
  v_mfma_f32_16x16x32_bf16 v[160:163], v[128:131], v[192:195], v[160:163]
  s_waitcnt lgkmcnt(4)
  v_mfma_f32_16x16x32_bf16 v[164:167], v[132:135], v[192:195], v[164:167]
  s_waitcnt lgkmcnt(2)
  v_mfma_f32_16x16x32_bf16 v[168:171], v[136:139], v[192:195], v[168:171]
  s_waitcnt lgkmcnt(0)
  v_mfma_f32_16x16x32_bf16 v[172:175], v[140:143], v[192:195], v[172:175]
  ds_read_b64_tr_b16 v[144:145], v22 offset:8192
  ds_read_b64_tr_b16 v[146:147], v23 offset:8192
  ds_read_b64_tr_b16 v[148:149], v24 offset:8192
  ds_read_b64_tr_b16 v[150:151], v25 offset:8192
  ds_read_b64_tr_b16 v[152:153], v26 offset:8192
  ds_read_b64_tr_b16 v[154:155], v27 offset:8192
  ds_read_b64_tr_b16 v[156:157], v28 offset:8192
  ds_read_b64_tr_b16 v[158:159], v29 offset:8192
  s_waitcnt lgkmcnt(6)
  v_mfma_f32_16x16x32_bf16 v[176:179], v[144:147], v[192:195], v[176:179]
  s_waitcnt lgkmcnt(4)
  v_mfma_f32_16x16x32_bf16 v[180:183], v[148:151], v[192:195], v[180:183]
  s_waitcnt lgkmcnt(2)
  v_mfma_f32_16x16x32_bf16 v[184:187], v[152:155], v[192:195], v[184:187]
  s_waitcnt lgkmcnt(0)
  v_mfma_f32_16x16x32_bf16 v[188:191], v[156:159], v[192:195], v[188:191]
  s_waitcnt vmcnt(5)
  buffer_load_dwordx4 v6, s[44:47], s67 offen offset:2048 nt lds
  s_waitcnt vmcnt(5)
  buffer_load_dwordx4 v6, s[44:47], s67 offen offset:3072 nt lds
  s_add_u32 m0, s65, 0
  s_add_u32 s67, s66, 327680
  buffer_load_dwordx4 v5, s[44:47], s67 offen offset:0 nt lds
  buffer_load_dwordx4 v5, s[44:47], s67 offen offset:1024 nt lds
  s_waitcnt vmcnt(7)
  buffer_load_dwordx4 v6, s[44:47], s67 offen offset:2048 nt lds
  s_waitcnt vmcnt(7)
  buffer_load_dwordx4 v6, s[44:47], s67 offen offset:3072 nt lds
  s_waitcnt vmcnt(7)
  s_add_u32 m0, s65, 4096
  s_add_u32 s67, s66, 344064
  buffer_load_dwordx4 v5, s[44:47], s67 offen offset:0 nt lds
  s_waitcnt vmcnt(7)
  buffer_load_dwordx4 v5, s[44:47], s67 offen offset:1024 nt lds
  s_waitcnt vmcnt(7)
  buffer_load_dwordx4 v6, s[44:47], s67 offen offset:2048 nt lds
  s_waitcnt vmcnt(7)
  buffer_load_dwordx4 v6, s[44:47], s67 offen offset:3072 nt lds
  ds_read_b128 v[192:195], v30 offset:576
  ds_read_b64_tr_b16 v[128:129], v14 offset:16384
  ds_read_b64_tr_b16 v[130:131], v15 offset:16384
  ds_read_b64_tr_b16 v[132:133], v16 offset:16384
  ds_read_b64_tr_b16 v[134:135], v17 offset:16384
  ds_read_b64_tr_b16 v[136:137], v18 offset:16384
  ds_read_b64_tr_b16 v[138:139], v19 offset:16384
  ds_read_b64_tr_b16 v[140:141], v20 offset:16384
  ds_read_b64_tr_b16 v[142:143], v21 offset:16384
  s_waitcnt lgkmcnt(6)
  v_mfma_f32_16x16x32_bf16 v[160:163], v[128:131], v[192:195], v[160:163]
  s_waitcnt lgkmcnt(4)
  v_mfma_f32_16x16x32_bf16 v[164:167], v[132:135], v[192:195], v[164:167]
  s_waitcnt lgkmcnt(2)
  v_mfma_f32_16x16x32_bf16 v[168:171], v[136:139], v[192:195], v[168:171]
  s_waitcnt lgkmcnt(0)
  v_mfma_f32_16x16x32_bf16 v[172:175], v[140:143], v[192:195], v[172:175]
  ds_read_b64_tr_b16 v[144:145], v22 offset:16384
  ds_read_b64_tr_b16 v[146:147], v23 offset:16384
  ds_read_b64_tr_b16 v[148:149], v24 offset:16384
  ds_read_b64_tr_b16 v[150:151], v25 offset:16384
  ds_read_b64_tr_b16 v[152:153], v26 offset:16384
  ds_read_b64_tr_b16 v[154:155], v27 offset:16384
  ds_read_b64_tr_b16 v[156:157], v28 offset:16384
  ds_read_b64_tr_b16 v[158:159], v29 offset:16384
  s_waitcnt lgkmcnt(6)
  v_mfma_f32_16x16x32_bf16 v[176:179], v[144:147], v[192:195], v[176:179]
  s_waitcnt lgkmcnt(4)
  v_mfma_f32_16x16x32_bf16 v[180:183], v[148:151], v[192:195], v[180:183]
  s_waitcnt lgkmcnt(2)
  v_mfma_f32_16x16x32_bf16 v[184:187], v[152:155], v[192:195], v[184:187]
  s_waitcnt lgkmcnt(0)
  v_mfma_f32_16x16x32_bf16 v[188:191], v[156:159], v[192:195], v[188:191]
  s_waitcnt vmcnt(7)
  s_add_u32 m0, s65, 8192
  s_add_u32 s67, s66, 360448
  buffer_load_dwordx4 v5, s[44:47], s67 offen offset:0 nt lds
  s_waitcnt vmcnt(7)
  buffer_load_dwordx4 v5, s[44:47], s67 offen offset:1024 nt lds
  s_waitcnt vmcnt(7)
  buffer_load_dwordx4 v6, s[44:47], s67 offen offset:2048 nt lds
  s_waitcnt vmcnt(7)
  buffer_load_dwordx4 v6, s[44:47], s67 offen offset:3072 nt lds
  s_waitcnt vmcnt(7)
  s_add_u32 m0, s65, 12288
  s_add_u32 s67, s66, 376832
  buffer_load_dwordx4 v5, s[44:47], s67 offen offset:0 nt lds
  s_waitcnt vmcnt(7)
  buffer_load_dwordx4 v5, s[44:47], s67 offen offset:1024 nt lds
  s_waitcnt vmcnt(7)
  buffer_load_dwordx4 v6, s[44:47], s67 offen offset:2048 nt lds
  s_waitcnt vmcnt(7)
  buffer_load_dwordx4 v6, s[44:47], s67 offen offset:3072 nt lds
  ds_read_b128 v[192:195], v30 offset:640
  ds_read_b64_tr_b16 v[128:129], v14 offset:0
  ds_read_b64_tr_b16 v[130:131], v15 offset:0
  ds_read_b64_tr_b16 v[132:133], v16 offset:0
  ds_read_b64_tr_b16 v[134:135], v17 offset:0
  ds_read_b64_tr_b16 v[136:137], v18 offset:0
  ds_read_b64_tr_b16 v[138:139], v19 offset:0
  ds_read_b64_tr_b16 v[140:141], v20 offset:0
  ds_read_b64_tr_b16 v[142:143], v21 offset:0
  s_waitcnt lgkmcnt(6)
  v_mfma_f32_16x16x32_bf16 v[160:163], v[128:131], v[192:195], v[160:163]
  s_waitcnt lgkmcnt(4)
  v_mfma_f32_16x16x32_bf16 v[164:167], v[132:135], v[192:195], v[164:167]
  s_waitcnt lgkmcnt(2)
  v_mfma_f32_16x16x32_bf16 v[168:171], v[136:139], v[192:195], v[168:171]
  s_waitcnt lgkmcnt(0)
  v_mfma_f32_16x16x32_bf16 v[172:175], v[140:143], v[192:195], v[172:175]
  ds_read_b64_tr_b16 v[144:145], v22 offset:0
  ds_read_b64_tr_b16 v[146:147], v23 offset:0
  ds_read_b64_tr_b16 v[148:149], v24 offset:0
  ds_read_b64_tr_b16 v[150:151], v25 offset:0
  ds_read_b64_tr_b16 v[152:153], v26 offset:0
  ds_read_b64_tr_b16 v[154:155], v27 offset:0
  ds_read_b64_tr_b16 v[156:157], v28 offset:0
  ds_read_b64_tr_b16 v[158:159], v29 offset:0
  s_waitcnt lgkmcnt(6)
  v_mfma_f32_16x16x32_bf16 v[176:179], v[144:147], v[192:195], v[176:179]
  s_waitcnt lgkmcnt(4)
  v_mfma_f32_16x16x32_bf16 v[180:183], v[148:151], v[192:195], v[180:183]
  s_waitcnt lgkmcnt(2)
  v_mfma_f32_16x16x32_bf16 v[184:187], v[152:155], v[192:195], v[184:187]
  s_waitcnt lgkmcnt(0)
  v_mfma_f32_16x16x32_bf16 v[188:191], v[156:159], v[192:195], v[188:191]
  s_waitcnt vmcnt(7)
  s_add_u32 m0, s65, 16384
  s_add_u32 s67, s66, 393216
  buffer_load_dwordx4 v5, s[44:47], s67 offen offset:0 nt lds
  s_waitcnt vmcnt(7)
  buffer_load_dwordx4 v5, s[44:47], s67 offen offset:1024 nt lds
  s_waitcnt vmcnt(7)
  buffer_load_dwordx4 v6, s[44:47], s67 offen offset:2048 nt lds
  s_waitcnt vmcnt(7)
  buffer_load_dwordx4 v6, s[44:47], s67 offen offset:3072 nt lds
  s_waitcnt vmcnt(7)
  s_add_u32 m0, s65, 20480
  s_add_u32 s67, s66, 409600
  buffer_load_dwordx4 v5, s[44:47], s67 offen offset:0 nt lds
  s_waitcnt vmcnt(7)
  buffer_load_dwordx4 v5, s[44:47], s67 offen offset:1024 nt lds
  s_waitcnt vmcnt(7)
  buffer_load_dwordx4 v6, s[44:47], s67 offen offset:2048 nt lds
  s_waitcnt vmcnt(7)
  buffer_load_dwordx4 v6, s[44:47], s67 offen offset:3072 nt lds
  ds_read_b128 v[192:195], v30 offset:704
  ds_read_b64_tr_b16 v[128:129], v14 offset:8192
  ds_read_b64_tr_b16 v[130:131], v15 offset:8192
  ds_read_b64_tr_b16 v[132:133], v16 offset:8192
  ds_read_b64_tr_b16 v[134:135], v17 offset:8192
  ds_read_b64_tr_b16 v[136:137], v18 offset:8192
  ds_read_b64_tr_b16 v[138:139], v19 offset:8192
  ds_read_b64_tr_b16 v[140:141], v20 offset:8192
  ds_read_b64_tr_b16 v[142:143], v21 offset:8192
  s_waitcnt lgkmcnt(6)
  v_mfma_f32_16x16x32_bf16 v[160:163], v[128:131], v[192:195], v[160:163]
  s_waitcnt lgkmcnt(4)
  v_mfma_f32_16x16x32_bf16 v[164:167], v[132:135], v[192:195], v[164:167]
  s_waitcnt lgkmcnt(2)
  v_mfma_f32_16x16x32_bf16 v[168:171], v[136:139], v[192:195], v[168:171]
  s_waitcnt lgkmcnt(0)
  v_mfma_f32_16x16x32_bf16 v[172:175], v[140:143], v[192:195], v[172:175]
  ds_read_b64_tr_b16 v[144:145], v22 offset:8192
  ds_read_b64_tr_b16 v[146:147], v23 offset:8192
  ds_read_b64_tr_b16 v[148:149], v24 offset:8192
  ds_read_b64_tr_b16 v[150:151], v25 offset:8192
  ds_read_b64_tr_b16 v[152:153], v26 offset:8192
  ds_read_b64_tr_b16 v[154:155], v27 offset:8192
  ds_read_b64_tr_b16 v[156:157], v28 offset:8192
  ds_read_b64_tr_b16 v[158:159], v29 offset:8192
  s_waitcnt lgkmcnt(6)
  v_mfma_f32_16x16x32_bf16 v[176:179], v[144:147], v[192:195], v[176:179]
  s_waitcnt lgkmcnt(4)
  v_mfma_f32_16x16x32_bf16 v[180:183], v[148:151], v[192:195], v[180:183]
  s_waitcnt lgkmcnt(2)
  v_mfma_f32_16x16x32_bf16 v[184:187], v[152:155], v[192:195], v[184:187]
  s_waitcnt lgkmcnt(0)
  v_mfma_f32_16x16x32_bf16 v[188:191], v[156:159], v[192:195], v[188:191]
  s_waitcnt vmcnt(7)
  s_add_u32 m0, s65, 0
  s_add_u32 s67, s66, 425984
  buffer_load_dwordx4 v5, s[44:47], s67 offen offset:0 nt lds
  s_waitcnt vmcnt(7)
  buffer_load_dwordx4 v5, s[44:47], s67 offen offset:1024 nt lds
  s_waitcnt vmcnt(7)
  buffer_load_dwordx4 v6, s[44:47], s67 offen offset:2048 nt lds
  s_waitcnt vmcnt(7)
  buffer_load_dwordx4 v6, s[44:47], s67 offen offset:3072 nt lds
  s_waitcnt vmcnt(7)
  s_add_u32 m0, s65, 4096
  s_add_u32 s67, s66, 442368
  buffer_load_dwordx4 v5, s[44:47], s67 offen offset:0 nt lds
  s_waitcnt vmcnt(7)
  buffer_load_dwordx4 v5, s[44:47], s67 offen offset:1024 nt lds
  s_waitcnt vmcnt(7)
  buffer_load_dwordx4 v6, s[44:47], s67 offen offset:2048 nt lds
  s_waitcnt vmcnt(7)
  buffer_load_dwordx4 v6, s[44:47], s67 offen offset:3072 nt lds
  ds_read_b128 v[192:195], v30 offset:768
  ds_read_b64_tr_b16 v[128:129], v14 offset:16384
  ds_read_b64_tr_b16 v[130:131], v15 offset:16384
  ds_read_b64_tr_b16 v[132:133], v16 offset:16384
  ds_read_b64_tr_b16 v[134:135], v17 offset:16384
  ds_read_b64_tr_b16 v[136:137], v18 offset:16384
  ds_read_b64_tr_b16 v[138:139], v19 offset:16384
  ds_read_b64_tr_b16 v[140:141], v20 offset:16384
  ds_read_b64_tr_b16 v[142:143], v21 offset:16384
  s_waitcnt lgkmcnt(6)
  v_mfma_f32_16x16x32_bf16 v[160:163], v[128:131], v[192:195], v[160:163]
  s_waitcnt lgkmcnt(4)
  v_mfma_f32_16x16x32_bf16 v[164:167], v[132:135], v[192:195], v[164:167]
  s_waitcnt lgkmcnt(2)
  v_mfma_f32_16x16x32_bf16 v[168:171], v[136:139], v[192:195], v[168:171]
  s_waitcnt lgkmcnt(0)
  v_mfma_f32_16x16x32_bf16 v[172:175], v[140:143], v[192:195], v[172:175]
  ds_read_b64_tr_b16 v[144:145], v22 offset:16384
  ds_read_b64_tr_b16 v[146:147], v23 offset:16384
  ds_read_b64_tr_b16 v[148:149], v24 offset:16384
  ds_read_b64_tr_b16 v[150:151], v25 offset:16384
  ds_read_b64_tr_b16 v[152:153], v26 offset:16384
  ds_read_b64_tr_b16 v[154:155], v27 offset:16384
  ds_read_b64_tr_b16 v[156:157], v28 offset:16384
  ds_read_b64_tr_b16 v[158:159], v29 offset:16384
  s_waitcnt lgkmcnt(6)
  v_mfma_f32_16x16x32_bf16 v[176:179], v[144:147], v[192:195], v[176:179]
  s_waitcnt lgkmcnt(4)
  v_mfma_f32_16x16x32_bf16 v[180:183], v[148:151], v[192:195], v[180:183]
  s_waitcnt lgkmcnt(2)
  v_mfma_f32_16x16x32_bf16 v[184:187], v[152:155], v[192:195], v[184:187]
  s_waitcnt lgkmcnt(0)
  v_mfma_f32_16x16x32_bf16 v[188:191], v[156:159], v[192:195], v[188:191]
  s_waitcnt vmcnt(7)
  s_add_u32 m0, s65, 8192
  s_add_u32 s67, s66, 458752
  buffer_load_dwordx4 v5, s[44:47], s67 offen offset:0 nt lds
  s_waitcnt vmcnt(7)
  buffer_load_dwordx4 v5, s[44:47], s67 offen offset:1024 nt lds
  s_waitcnt vmcnt(7)
  buffer_load_dwordx4 v6, s[44:47], s67 offen offset:2048 nt lds
  s_waitcnt vmcnt(7)
  buffer_load_dwordx4 v6, s[44:47], s67 offen offset:3072 nt lds
  s_waitcnt vmcnt(7)
  s_add_u32 m0, s65, 12288
  s_add_u32 s67, s66, 475136
  buffer_load_dwordx4 v5, s[44:47], s67 offen offset:0 nt lds
  s_waitcnt vmcnt(7)
  buffer_load_dwordx4 v5, s[44:47], s67 offen offset:1024 nt lds
  s_waitcnt vmcnt(7)
  buffer_load_dwordx4 v6, s[44:47], s67 offen offset:2048 nt lds
  s_waitcnt vmcnt(7)
  buffer_load_dwordx4 v6, s[44:47], s67 offen offset:3072 nt lds
  ds_read_b128 v[192:195], v30 offset:832
  ds_read_b64_tr_b16 v[128:129], v14 offset:0
  ds_read_b64_tr_b16 v[130:131], v15 offset:0
  ds_read_b64_tr_b16 v[132:133], v16 offset:0
  ds_read_b64_tr_b16 v[134:135], v17 offset:0
  ds_read_b64_tr_b16 v[136:137], v18 offset:0
  ds_read_b64_tr_b16 v[138:139], v19 offset:0
  ds_read_b64_tr_b16 v[140:141], v20 offset:0
  ds_read_b64_tr_b16 v[142:143], v21 offset:0
  s_waitcnt lgkmcnt(6)
  v_mfma_f32_16x16x32_bf16 v[160:163], v[128:131], v[192:195], v[160:163]
  s_waitcnt lgkmcnt(4)
  v_mfma_f32_16x16x32_bf16 v[164:167], v[132:135], v[192:195], v[164:167]
  s_waitcnt lgkmcnt(2)
  v_mfma_f32_16x16x32_bf16 v[168:171], v[136:139], v[192:195], v[168:171]
  s_waitcnt lgkmcnt(0)
  v_mfma_f32_16x16x32_bf16 v[172:175], v[140:143], v[192:195], v[172:175]
  ds_read_b64_tr_b16 v[144:145], v22 offset:0
  ds_read_b64_tr_b16 v[146:147], v23 offset:0
  ds_read_b64_tr_b16 v[148:149], v24 offset:0
  ds_read_b64_tr_b16 v[150:151], v25 offset:0
  ds_read_b64_tr_b16 v[152:153], v26 offset:0
  ds_read_b64_tr_b16 v[154:155], v27 offset:0
  ds_read_b64_tr_b16 v[156:157], v28 offset:0
  ds_read_b64_tr_b16 v[158:159], v29 offset:0
  s_waitcnt lgkmcnt(6)
  v_mfma_f32_16x16x32_bf16 v[176:179], v[144:147], v[192:195], v[176:179]
  s_waitcnt lgkmcnt(4)
  v_mfma_f32_16x16x32_bf16 v[180:183], v[148:151], v[192:195], v[180:183]
  s_waitcnt lgkmcnt(2)
  v_mfma_f32_16x16x32_bf16 v[184:187], v[152:155], v[192:195], v[184:187]
  s_waitcnt lgkmcnt(0)
  v_mfma_f32_16x16x32_bf16 v[188:191], v[156:159], v[192:195], v[188:191]
  s_waitcnt vmcnt(7)
  s_add_u32 m0, s65, 16384
  s_add_u32 s67, s66, 491520
  buffer_load_dwordx4 v5, s[44:47], s67 offen offset:0 nt lds
  s_waitcnt vmcnt(7)
  buffer_load_dwordx4 v5, s[44:47], s67 offen offset:1024 nt lds
  s_waitcnt vmcnt(7)
  buffer_load_dwordx4 v6, s[44:47], s67 offen offset:2048 nt lds
  s_waitcnt vmcnt(7)
  buffer_load_dwordx4 v6, s[44:47], s67 offen offset:3072 nt lds
  s_waitcnt vmcnt(7)
  s_add_u32 m0, s65, 20480
  s_add_u32 s67, s66, 507904
  buffer_load_dwordx4 v5, s[44:47], s67 offen offset:0 nt lds
  s_waitcnt vmcnt(7)
  buffer_load_dwordx4 v5, s[44:47], s67 offen offset:1024 nt lds
  s_waitcnt vmcnt(7)
  buffer_load_dwordx4 v6, s[44:47], s67 offen offset:2048 nt lds
  s_waitcnt vmcnt(7)
  buffer_load_dwordx4 v6, s[44:47], s67 offen offset:3072 nt lds
  ds_read_b128 v[192:195], v30 offset:896
  ds_read_b64_tr_b16 v[128:129], v14 offset:8192
  ds_read_b64_tr_b16 v[130:131], v15 offset:8192
  ds_read_b64_tr_b16 v[132:133], v16 offset:8192
  ds_read_b64_tr_b16 v[134:135], v17 offset:8192
  ds_read_b64_tr_b16 v[136:137], v18 offset:8192
  ds_read_b64_tr_b16 v[138:139], v19 offset:8192
  ds_read_b64_tr_b16 v[140:141], v20 offset:8192
  ds_read_b64_tr_b16 v[142:143], v21 offset:8192
  s_waitcnt lgkmcnt(6)
  v_mfma_f32_16x16x32_bf16 v[160:163], v[128:131], v[192:195], v[160:163]
  s_waitcnt lgkmcnt(4)
  v_mfma_f32_16x16x32_bf16 v[164:167], v[132:135], v[192:195], v[164:167]
  s_waitcnt lgkmcnt(2)
  v_mfma_f32_16x16x32_bf16 v[168:171], v[136:139], v[192:195], v[168:171]
  s_waitcnt lgkmcnt(0)
  v_mfma_f32_16x16x32_bf16 v[172:175], v[140:143], v[192:195], v[172:175]
  ds_read_b64_tr_b16 v[144:145], v22 offset:8192
  ds_read_b64_tr_b16 v[146:147], v23 offset:8192
  ds_read_b64_tr_b16 v[148:149], v24 offset:8192
  ds_read_b64_tr_b16 v[150:151], v25 offset:8192
  ds_read_b64_tr_b16 v[152:153], v26 offset:8192
  ds_read_b64_tr_b16 v[154:155], v27 offset:8192
  ds_read_b64_tr_b16 v[156:157], v28 offset:8192
  ds_read_b64_tr_b16 v[158:159], v29 offset:8192
  s_waitcnt lgkmcnt(6)
  v_mfma_f32_16x16x32_bf16 v[176:179], v[144:147], v[192:195], v[176:179]
  s_waitcnt lgkmcnt(4)
  v_mfma_f32_16x16x32_bf16 v[180:183], v[148:151], v[192:195], v[180:183]
  s_waitcnt lgkmcnt(2)
  v_mfma_f32_16x16x32_bf16 v[184:187], v[152:155], v[192:195], v[184:187]
  s_waitcnt lgkmcnt(0)
  v_mfma_f32_16x16x32_bf16 v[188:191], v[156:159], v[192:195], v[188:191]
  s_waitcnt vmcnt(0)
  ds_read_b128 v[192:195], v30 offset:960
  ds_read_b64_tr_b16 v[128:129], v14 offset:16384
  ds_read_b64_tr_b16 v[130:131], v15 offset:16384
  ds_read_b64_tr_b16 v[132:133], v16 offset:16384
  ds_read_b64_tr_b16 v[134:135], v17 offset:16384
  ds_read_b64_tr_b16 v[136:137], v18 offset:16384
  ds_read_b64_tr_b16 v[138:139], v19 offset:16384
  ds_read_b64_tr_b16 v[140:141], v20 offset:16384
  ds_read_b64_tr_b16 v[142:143], v21 offset:16384
  s_waitcnt lgkmcnt(6)
  v_mfma_f32_16x16x32_bf16 v[160:163], v[128:131], v[192:195], v[160:163]
  s_waitcnt lgkmcnt(4)
  v_mfma_f32_16x16x32_bf16 v[164:167], v[132:135], v[192:195], v[164:167]
  s_waitcnt lgkmcnt(2)
  v_mfma_f32_16x16x32_bf16 v[168:171], v[136:139], v[192:195], v[168:171]
  s_waitcnt lgkmcnt(0)
  v_mfma_f32_16x16x32_bf16 v[172:175], v[140:143], v[192:195], v[172:175]
  ds_read_b64_tr_b16 v[144:145], v22 offset:16384
  ds_read_b64_tr_b16 v[146:147], v23 offset:16384
  ds_read_b64_tr_b16 v[148:149], v24 offset:16384
  ds_read_b64_tr_b16 v[150:151], v25 offset:16384
  ds_read_b64_tr_b16 v[152:153], v26 offset:16384
  ds_read_b64_tr_b16 v[154:155], v27 offset:16384
  ds_read_b64_tr_b16 v[156:157], v28 offset:16384
  ds_read_b64_tr_b16 v[158:159], v29 offset:16384
  s_waitcnt lgkmcnt(6)
  v_mfma_f32_16x16x32_bf16 v[176:179], v[144:147], v[192:195], v[176:179]
  s_waitcnt lgkmcnt(4)
  v_mfma_f32_16x16x32_bf16 v[180:183], v[148:151], v[192:195], v[180:183]
  s_waitcnt lgkmcnt(2)
  v_mfma_f32_16x16x32_bf16 v[184:187], v[152:155], v[192:195], v[184:187]
  s_waitcnt lgkmcnt(0)
  v_mfma_f32_16x16x32_bf16 v[188:191], v[156:159], v[192:195], v[188:191]
  s_lshl_b32 s64, s3, 10
  v_lshlrev_b32 v232, 9, v8
  v_lshl_add_u32 v232, v7, 4, v232
  v_add_u32 v232, s64, v232
  v_lshlrev_b32 v234, 4, v1
  s_lshl_b32 s64, s38, 10
  s_add_u32 s64, s64, 131072
  s_mov_b32 exec_lo, 0x30003
  s_mov_b32 exec_hi, 0x30003
  ds_write_b128 v232, v[160:163] offset:2048
  ds_write_b128 v232, v[164:167] offset:2112
  ds_write_b128 v232, v[168:171] offset:2176
  ds_write_b128 v232, v[172:175] offset:2240
  ds_write_b128 v232, v[176:179] offset:2304
  ds_write_b128 v232, v[180:183] offset:2368
  s_nop 3
  ds_write_b128 v232, v[184:187] offset:2432
  ds_write_b128 v232, v[188:191] offset:2496
  s_mov_b64 exec, 1
  ds_add_rtn_u32 v233, v2, v3 offset:20
  s_mov_b64 exec, -1
  s_waitcnt lgkmcnt(0)
  v_readfirstlane_b32 s67, v233
  s_cmp_eq_u32 s67, 3
  s_cbranch_scc0 L_s_notlast
  ds_read_b128 v[32:35], v234 offset:2048
  ds_read_b128 v[36:39], v234 offset:3072
  ds_read_b128 v[40:43], v234 offset:4096
  ds_read_b128 v[44:47], v234 offset:5120
  s_waitcnt lgkmcnt(2)
  v_pk_add_f32 v[32:33], v[32:33], v[36:37]
  v_pk_add_f32 v[34:35], v[34:35], v[38:39]
  s_waitcnt lgkmcnt(0)
  v_pk_add_f32 v[40:41], v[40:41], v[44:45]
  v_pk_add_f32 v[42:43], v[42:43], v[46:47]
  v_pk_add_f32 v[32:33], v[32:33], v[40:41]
  v_pk_add_f32 v[34:35], v[34:35], v[42:43]
  v_min_u32 v32, -2, v32
  v_min_u32 v33, -2, v33
  v_min_u32 v34, -2, v34
  v_min_u32 v35, -2, v35
  buffer_store_dwordx4 v[32:35], v234, s[52:55], s64 offen sc1
L_s_notlast:
L_fin:
L_end:
  s_endpgm
.section .rodata,"a"
.p2align 6
.amdhsa_kernel sequential_preLN__gqa_block_cached__geglu_ffn__decode_kernel
  .amdhsa_next_free_vgpr 256
  .amdhsa_next_free_sgpr 102
  .amdhsa_accum_offset 256
  .amdhsa_group_segment_fixed_size 0
  .amdhsa_kernarg_size 96
  .amdhsa_user_sgpr_count 2
  .amdhsa_user_sgpr_kernarg_segment_ptr 1
  .amdhsa_system_sgpr_workgroup_id_x 1
  .amdhsa_float_denorm_mode_32 3
  .amdhsa_float_denorm_mode_16_64 3
.end_amdhsa_kernel
```
